```python
import torch

def _softmax(x, axis=-1):
    return torch.softmax(x, dim=axis)
def _gelu(x):
    return torch.nn.functional.gelu(x, approximate="tanh")
def _silu(x):
    return torch.nn.functional.silu(x)
def _sigmoid(x):
    return torch.sigmoid(x)
def _layernorm(x, axis=-1, eps=1e-5):
    m = x.mean(dim=axis, keepdim=True)
    v = x.var(dim=axis, keepdim=True, unbiased=False)
    return (x - m) / torch.sqrt(v + eps)
def _scatter_add(tgt, idx, src, axis=0):
    return tgt.clone().index_add_(axis, idx, src)
def _segment_sum(src, seg, n):
    out = torch.zeros((n,) + src.shape[1:], dtype=src.dtype)
    return out.index_add_(0, seg, src)
def _pad(x, pw):
    flat = tuple(v for pair in reversed(pw) for v in pair)
    return torch.nn.functional.pad(x, flat)

kernel_name = 'parallel_sum__spectral_gfnet__dense_activation_silu__prompt'

def setup_inputs():

    _w = (lambda a: (lambda t: t.to(torch.bfloat16) if t.is_floating_point() else t)(torch.as_tensor(a)))
    def _A_setup():
        B, S, D = 1, 2048, 512
        Df = D // 2 + 1
        return {
            "x": _w((lambda *s: torch.randn(*s, dtype=torch.bfloat16) * 0.05)(B, S, D)),
            "w_r": _w((lambda *s: torch.randn(*s, dtype=torch.bfloat16) * 0.8)(S, Df) * 0.02),
            "w_i": _w((lambda *s: torch.randn(*s, dtype=torch.bfloat16) * 0.8)(S, Df) * 0.02),
        }
    _A_in = _A_setup()

    def _B_setup():
        B, S, D, F = 1, 2048, 512, 1792
        return {
            "x": _w((lambda *s: torch.randn(*s, dtype=torch.bfloat16) * 0.05)(B, S, D)),
            "w1": _w((lambda *s: torch.randn(*s, dtype=torch.bfloat16) * 0.8)(D, F) * (D ** -0.5)),
            "w2": _w((lambda *s: torch.randn(*s, dtype=torch.bfloat16) * 0.1)(F, D) * (F ** -0.5)),
        }
    _B_in = _B_setup()

    return {
        "A_x": _A_in["x"],
        "A_w_r": _A_in["w_r"],
        "A_w_i": _A_in["w_i"],
        "B_x": _B_in["x"],
        "B_w1": _B_in["w1"],
        "B_w2": _B_in["w2"],
    }

def reference(A_x, A_w_r, A_w_i, B_x, B_w1, B_w2):
    def _A_ref(x, w_r, w_i):
        B, S, D = x.shape
        X = (lambda x, axes=(-2,-1): torch.fft.rfft2(x.float(), dim=axes))(x, axes=(-2, -1))
        W = w_r + 1j * w_i
        X = X * W
        y = (lambda x, s, axes=(-2,-1): torch.fft.irfft2(x, s=s, dim=axes).to(torch.bfloat16))(X, (S, D), axes=(-2, -1))
        return y

    def _B_ref(x, w1, w2):
        h = torch.einsum("bsd,df->bsf", x, w1)
        h = _silu(h)
        out = torch.einsum("bsf,fd->bsd", h, w2)
        return out

    x = A_x
    xn = _layernorm(x, axis=-1)
    return x + _A_ref(xn, A_w_r, A_w_i) + _B_ref(xn, B_w1, B_w2)
```

```asm
; @launch grid=(256,1,1) block=(256,1,1) lds=163840
.amdgcn_target "amdgcn-amd-amdhsa--gfx950"
.text
.globl parallel_sum__spectral_gfnet__dense_activation_silu__prompt_kernel
.p2align 8
.type parallel_sum__spectral_gfnet__dense_activation_silu__prompt_kernel,@function
parallel_sum__spectral_gfnet__dense_activation_silu__prompt_kernel:
    s_cmp_ge_u32 s2, 256
    s_cbranch_scc1 L_end
    s_load_dwordx2 s[4:5], s[0:1], 0
    s_load_dwordx4 s[52:55], s[0:1], 32
    s_load_dwordx2 s[16:17], s[0:1], 64
    s_load_dwordx4 s[56:59], s[0:1], 8
    s_load_dwordx2 s[28:29], s[0:1], 48
    v_and_b32 v1, 63, v0
    v_lshrrev_b32 v58, 6, v0
    v_lshlrev_b32 v26, 4, v1
    v_readfirstlane_b32 s33, v58
    s_getpc_b64 s[50:51]
    s_lshr_b32 s60, s2, 3
    s_lshl_b32 s60, s60, 11
    s_and_b32 s61, s33, 1
    s_lshl_b32 s61, s61, 10
    s_add_u32 s60, s60, s61
    s_min_u32 s60, s60, L_end-parallel_sum__spectral_gfnet__dense_activation_silu__prompt_kernel-1280
    s_add_u32 s50, s50, s60
    s_addc_u32 s51, s51, 0
    v_mov_b32 v59, s51
    v_add_co_u32 v58, vcc, s50, v26
    s_nop 1
    v_addc_co_u32 v59, vcc, 0, v59, vcc
    global_load_dwordx4 v[200:203], v[58:59], off
    s_and_b32 s50, s2, 7
    s_lshr_b32 s51, s2, 3
    s_lshr_b32 s60, s50, 1
    s_lshl_b32 s60, s60, 2
    s_lshr_b32 s61, s51, 3
    s_add_u32 s34, s60, s61
    s_and_b32 s62, s51, 7
    s_and_b32 s36, s62, 1
    s_and_b32 s63, s50, 1
    s_lshl_b32 s35, s63, 2
    s_lshr_b32 s60, s62, 1
    s_add_u32 s35, s35, s60
    s_add_u32 s37, s62, s61
    s_add_u32 s37, s37, 0
    s_and_b32 s37, s37, 7
    s_lshl_b32 s38, s50, 2
    s_add_u32 s38, s38, s61
    s_mov_b32 s39, s62
    s_mov_b32 s40, s38
    s_mov_b32 s41, s62
    s_lshl_b32 s63, s63, 3
    s_add_u32 s63, s63, s62
    s_lshl_b32 s60, s34, 2
    s_add_u32 s60, s60, s33
    s_lshl_b32 s42, s60, 10
    s_lshl_b32 s47, s33, 13
    s_mul_i32 s60, s35, 320
    s_and_b32 s50, s35, 1
    s_lshl_b32 s51, s50, 6
    s_add_u32 s51, s51, s60
    s_lshl_b32 s50, s50, 8
    s_sub_u32 s43, s60, s50
    s_add_u32 s43, s43, 256
    s_lshl_b32 s61, s35, 7
    s_add_u32 s61, s61, 2560
    s_cmp_eq_u32 s36, 0
    s_cselect_b32 s44, s51, s61
    s_mul_i32 s60, s42, 112
    s_add_u32 s60, s60, 5242880
    s_lshl_b32 s61, s43, 5
    s_add_u32 s45, s60, s61
    s_lshl_b32 s61, s44, 5
    s_add_u32 s46, s60, s61
    v_lshrrev_b32 v58, 3, v1
    v_and_b32 v59, 7, v1
    v_lshrrev_b32 v60, 4, v1
    v_xor_b32 v59, v59, v60
    v_lshlrev_b32 v59, 4, v59
    v_lshl_add_u32 v2, v58, 16, v59
    v_add_u32 v2, s42, v2
    s_lshl_b32 s3, s37, 7
    v_xor_b32 v3, 64, v2
    v_add_u32 v4, 1046528, v2
    v_add_u32 v5, 1569792, v3
    v_add_u32 v3, 523264, v3
    v_lshrrev_b32 v59, 5, v1
    v_and_b32 v60, 31, v1
    v_lshlrev_b32 v60, 4, v60
    v_lshl_add_u32 v60, v59, 16, v60
    s_lshl_b32 s60, s63, 17
    s_xor_b32 s61, s42, 4096
    s_add_u32 s60, s60, s61
    s_lshl_b32 s61, s33, 4
    v_add_u32 v58, s61, v58
    v_mul_u32_u24 v58, 3584, v58
    v_and_b32 v59, 7, v1
    v_lshlrev_b32 v59, 4, v59
    v_and_b32 v61, 16, v1
    v_lshlrev_b32 v61, 2, v61
    v_xor_b32 v59, v59, v61
    v_add3_u32 v6, v58, v59, s44
    v_add_u32 v7, 27648, v6
    v_lshrrev_b32 v58, 2, v1
    v_add_u32 v58, s61, v58
    v_mul_u32_u24 v58, 3584, v58
    v_and_b32 v59, 3, v1
    v_lshl_add_u32 v8, v59, 4, v58
    v_add_u32 v8, s43, v8
    s_waitcnt lgkmcnt(0)
    s_mov_b32 s6, 2097152
    s_mov_b32 s7, 0x20000
    s_mov_b32 s18, 16777216
    s_mov_b32 s19, 0x20000
    buffer_load_dword v240, off, s[16:19], 0 offset:0
    buffer_load_dwordx4 v[192:195], v60, s[4:7], s60 offen
    buffer_load_dwordx4 v[196:199], v60, s[4:7], s60 offen offset:512
    s_mov_b32 s8, s52
    s_mov_b32 s9, s53
    s_mov_b32 s10, 1835008
    s_mov_b32 s11, 0x20000
    s_mov_b32 s12, s54
    s_mov_b32 s13, s55
    s_mov_b32 s14, 1835008
    s_mov_b32 s15, 0x20000
    s_mov_b32 s18, 16777216
    s_mov_b32 s19, 0x20000
    s_mov_b32 s20, s56
    s_mov_b32 s21, s57
    s_mov_b32 s22, 1052672
    s_mov_b32 s23, 0x20000
    s_mov_b32 s24, s58
    s_mov_b32 s25, s59
    s_mov_b32 s26, 1052672
    s_mov_b32 s27, 0x20000
    s_mov_b32 s30, 2097152
    s_mov_b32 s31, 0x20000
    s_mov_b32 s49, s63
    s_lshl_b32 s61, s33, 10
    s_lshl_b32 s62, s33, 11
    s_lshl_b32 s48, s41, 7
    s_lshl_b32 s56, s33, 14
    s_lshr_b32 s50, s34, 2
    s_lshl_b32 s50, s50, 4
    s_add_u32 s50, s50, s63
    s_lshl_b32 s50, s50, 2
    s_add_u32 s50, s50, s33
    s_lshl_b32 s50, s50, 12
    s_add_u32 s57, s50, 13631488
    s_mul_i32 s50, s41, 7
    s_lshr_b32 s50, s50, 1
    s_and_b32 s51, s40, 3
    s_mul_i32 s51, s51, 7
    s_add_u32 s63, s50, s51
    s_and_b32 s50, s2, 7
    s_add_u32 s63, s63, s50
    s_cmp_ge_u32 s63, 28
    s_cselect_b32 s50, 28, 0
    s_sub_u32 s63, s63, s50
    s_cmp_eq_u32 s36, 1
    s_cbranch_scc1 L_typeB
    s_add_u32 m0, s62, 49152
    s_add_u32 s51, s3, 0
    s_and_b32 s51, s51, 0x380
    s_mul_i32 s51, s51, 1792
    buffer_load_dwordx4 v6, s[8:11], s51 offen offset:0  lds
    buffer_load_dwordx4 v7, s[8:11], s51 offen offset:1024  lds
    s_add_u32 m0, s62, 57216
    s_nop 0
    buffer_load_dwordx4 v6, s[8:11], s51 offen offset:128  lds
    buffer_load_dwordx4 v7, s[8:11], s51 offen offset:1152  lds
    s_add_u32 m0, s61, 110592
    s_nop 0
    buffer_load_dwordx4 v8, s[8:11], s51 offen  lds
    s_add_u32 m0, s47, 4096
    s_add_u32 s50, s3, 0
    s_and_b32 s50, s50, 0x380
    buffer_load_dwordx4 v2, s[4:7], s50 offen offset:0  lds
    buffer_load_dwordx4 v3, s[4:7], s50 offen offset:1024  lds
    buffer_load_dwordx4 v4, s[4:7], s50 offen offset:2048  lds
    buffer_load_dwordx4 v5, s[4:7], s50 offen offset:3072  lds
    v_and_b32 v58, 31, v1
    v_lshrrev_b32 v59, 5, v1
    v_bfe_u32 v60, v1, 1, 3
    v_xor_b32 v60, v60, v59
    v_lshlrev_b32 v60, 4, v60
    v_lshl_add_u32 v60, v58, 7, v60
    v_add_u32 v9, s47, v60
    v_xor_b32 v10, 32, v9
    v_xor_b32 v11, 64, v9
    v_xor_b32 v12, 96, v9
    s_add_u32 s50, s56, 98304
    v_add_u32 v232, s50, v60
    v_xor_b32 v233, 32, v232
    v_xor_b32 v234, 64, v232
    v_xor_b32 v235, 96, v232
    v_bfe_u32 v58, v1, 2, 2
    v_lshl_add_u32 v60, v59, 3, v58
    v_and_b32 v61, 3, v1
    v_lshlrev_b32 v61, 3, v61
    v_and_b32 v62, 16, v1
    v_lshl_add_u32 v61, v62, 1, v61
    v_lshl_add_u32 v17, v60, 6, v61
    v_add_u32 v17, 98304, v17
    v_lshl_add_u32 v61, v60, 7, v61
    v_and_b32 v62, 8, v1
    v_lshl_add_u32 v61, v62, 3, v61
    v_add_u32 v13, 49152, v61
    v_xor_b32 v14, 64, v13
    v_add_u32 v15, 98304, v61
    v_xor_b32 v16, 64, v15
    s_lshl_b32 s50, s33, 11
    v_add_u32 v21, s50, v15
    v_add_u32 v22, s50, v16
    v_add_u32 v19, s50, v13
    v_add_u32 v20, s50, v14
    v_add_u32 v237, s61, v17
    v_add_u32 v18, 49152, v26
    v_mov_b32 v56, 0x3f803f80
    v_mov_b32 v57, 0x3f803f80
    v_xor_b32 v156, 0x2000, v9
    v_xor_b32 v157, 0x2000, v10
    v_xor_b32 v158, 0x2000, v11
    v_xor_b32 v159, 0x2000, v12
    s_xor_b32 s54, s56, 0x4000
    s_sub_u32 s54, s54, s56
    v_add_u32 v185, s54, v232
    v_add_u32 v186, s54, v233
    v_add_u32 v187, s54, v234
    v_add_u32 v188, s54, v235
    s_and_b32 s54, s33, 1
    s_lshl_b32 s54, s54, 13
    v_add_u32 v13, s54, v13
    v_add_u32 v14, s54, v14
    s_lshl_b32 s54, s54, 1
    v_add_u32 v15, s54, v15
    v_add_u32 v16, s54, v16
    v_bfe_u32 v208, v1, 4, 1
    v_bfe_u32 v209, v1, 3, 1
    v_bfe_u32 v210, v1, 2, 1
    v_bfe_u32 v211, v1, 1, 1
    v_lshl_add_u32 v212, v209, 1, v211
    v_lshl_add_u32 v212, v210, 2, v212
    v_lshl_add_u32 v212, v208, 3, v212
    s_lshl_b32 s98, s33, 4
    v_add_u32 v212, s98, v212
    v_and_b32 v213, 1, v1
    v_cvt_f32_u32 v216, v213
    v_mul_f32 v216, 0x3e800000, v216
    v_cvt_f32_u32 v217, v212
    v_mul_f32 v217, 0x3c800000, v217
    v_lshrrev_b32 v212, 5, v1
    v_lshlrev_b32 v212, 2, v212
    v_cvt_f32_u32 v212, v212
    v_fmac_f32 v216, v212, v217
    s_mov_b32 s98, 0x80008000
    v_mul_lo_u32 v214, v211, s98
    v_cos_f32 v218, v216
    v_sin_f32 v219, v216
    v_add_f32 v216, v216, v217
    v_cos_f32 v220, v216
    v_sin_f32 v221, v216
    v_add_f32 v216, v216, v217
    v_cvt_pk_bf16_f32 v222, v218, v219
    v_xor_b32 v223, v222, v214
    v_accvgpr_write_b32 a128, v222
    v_accvgpr_write_b32 a144, v223
    v_cos_f32 v218, v216
    v_sin_f32 v219, v216
    v_add_f32 v216, v216, v217
    v_cvt_pk_bf16_f32 v224, v220, v221
    v_xor_b32 v225, v224, v214
    v_accvgpr_write_b32 a129, v224
    v_accvgpr_write_b32 a145, v225
    v_cos_f32 v220, v216
    v_sin_f32 v221, v216
    v_fmac_f32 v216, 0x40a00000, v217
    v_cvt_pk_bf16_f32 v222, v218, v219
    v_xor_b32 v223, v222, v214
    v_accvgpr_write_b32 a130, v222
    v_accvgpr_write_b32 a146, v223
    v_cos_f32 v218, v216
    v_sin_f32 v219, v216
    v_add_f32 v216, v216, v217
    v_cvt_pk_bf16_f32 v224, v220, v221
    v_xor_b32 v225, v224, v214
    v_accvgpr_write_b32 a131, v224
    v_accvgpr_write_b32 a147, v225
    v_cos_f32 v220, v216
    v_sin_f32 v221, v216
    v_add_f32 v216, v216, v217
    v_cvt_pk_bf16_f32 v222, v218, v219
    v_xor_b32 v223, v222, v214
    v_accvgpr_write_b32 a132, v222
    v_accvgpr_write_b32 a148, v223
    v_cos_f32 v218, v216
    v_sin_f32 v219, v216
    v_add_f32 v216, v216, v217
    v_cvt_pk_bf16_f32 v224, v220, v221
    v_xor_b32 v225, v224, v214
    v_accvgpr_write_b32 a133, v224
    v_accvgpr_write_b32 a149, v225
    v_cos_f32 v220, v216
    v_sin_f32 v221, v216
    v_fmac_f32 v216, 0x40a00000, v217
    v_cvt_pk_bf16_f32 v222, v218, v219
    v_xor_b32 v223, v222, v214
    v_accvgpr_write_b32 a134, v222
    v_accvgpr_write_b32 a150, v223
    v_cos_f32 v218, v216
    v_sin_f32 v219, v216
    v_add_f32 v216, v216, v217
    v_cvt_pk_bf16_f32 v224, v220, v221
    v_xor_b32 v225, v224, v214
    v_accvgpr_write_b32 a135, v224
    v_accvgpr_write_b32 a151, v225
    v_cos_f32 v220, v216
    v_sin_f32 v221, v216
    v_add_f32 v216, v216, v217
    v_cvt_pk_bf16_f32 v222, v218, v219
    v_xor_b32 v223, v222, v214
    v_accvgpr_write_b32 a136, v222
    v_accvgpr_write_b32 a152, v223
    v_cos_f32 v218, v216
    v_sin_f32 v219, v216
    v_add_f32 v216, v216, v217
    v_cvt_pk_bf16_f32 v224, v220, v221
    v_xor_b32 v225, v224, v214
    v_accvgpr_write_b32 a137, v224
    v_accvgpr_write_b32 a153, v225
    v_cos_f32 v220, v216
    v_sin_f32 v221, v216
    v_fmac_f32 v216, 0x40a00000, v217
    v_cvt_pk_bf16_f32 v222, v218, v219
    v_xor_b32 v223, v222, v214
    v_accvgpr_write_b32 a138, v222
    v_accvgpr_write_b32 a154, v223
    v_cos_f32 v218, v216
    v_sin_f32 v219, v216
    v_add_f32 v216, v216, v217
    v_cvt_pk_bf16_f32 v224, v220, v221
    v_xor_b32 v225, v224, v214
    v_accvgpr_write_b32 a139, v224
    v_accvgpr_write_b32 a155, v225
    v_cos_f32 v220, v216
    v_sin_f32 v221, v216
    v_add_f32 v216, v216, v217
    v_cvt_pk_bf16_f32 v222, v218, v219
    v_xor_b32 v223, v222, v214
    v_accvgpr_write_b32 a140, v222
    v_accvgpr_write_b32 a156, v223
    v_cos_f32 v218, v216
    v_sin_f32 v219, v216
    v_add_f32 v216, v216, v217
    v_cvt_pk_bf16_f32 v224, v220, v221
    v_xor_b32 v225, v224, v214
    v_accvgpr_write_b32 a141, v224
    v_accvgpr_write_b32 a157, v225
    v_cos_f32 v220, v216
    v_sin_f32 v221, v216
    v_cvt_pk_bf16_f32 v222, v218, v219
    v_xor_b32 v223, v222, v214
    v_accvgpr_write_b32 a142, v222
    v_accvgpr_write_b32 a158, v223
    v_cvt_pk_bf16_f32 v224, v220, v221
    v_xor_b32 v225, v224, v214
    v_accvgpr_write_b32 a143, v224
    v_accvgpr_write_b32 a159, v225
    v_bfe_u32 v213, v1, 3, 2
    v_lshl_add_u32 v213, v213, 1, v210
    v_and_b32 v208, 1, v1
    v_lshl_add_u32 v213, v213, 1, v208
    s_mov_b32 s98, 0x80008000
    v_mul_lo_u32 v214, v208, s98
    s_lshl_b32 s98, s33, 4
    v_add_u32 v213, s98, v213
    v_cvt_f32_u32 v213, v213
    v_mul_f32 v217, 0x3c800000, v213
    v_cvt_f32_u32 v216, v211
    v_mul_f32 v216, 0xbe800000, v216
    v_cvt_f32_u32 v208, s38
    v_mul_f32 v208, 0x3a000000, v208
    v_fmac_f32 v216, v208, v213
    v_fmac_f32 v216, v212, v217
    v_cos_f32 v218, v216
    v_sin_f32 v219, v216
    v_add_f32 v216, v216, v217
    v_cos_f32 v220, v216
    v_sin_f32 v221, v216
    v_add_f32 v216, v216, v217
    v_cvt_pk_bf16_f32 v222, v218, -v219
    s_waitcnt vmcnt(9)
    v_lshlrev_b32 v96, 16, v192
    v_and_b32 v97, 0xffff0000, v192
    v_lshlrev_b32 v98, 16, v193
    v_and_b32 v99, 0xffff0000, v193
    v_lshlrev_b32 v100, 16, v194
    v_and_b32 v101, 0xffff0000, v194
    v_lshlrev_b32 v102, 16, v195
    v_and_b32 v103, 0xffff0000, v195
    v_lshlrev_b32 v104, 16, v196
    v_and_b32 v105, 0xffff0000, v196
    v_lshlrev_b32 v106, 16, v197
    v_and_b32 v107, 0xffff0000, v197
    v_lshlrev_b32 v108, 16, v198
    v_and_b32 v109, 0xffff0000, v198
    v_lshlrev_b32 v110, 16, v199
    v_and_b32 v111, 0xffff0000, v199
    v_add_f32 v112, v96, v97
    v_add_f32 v113, v98, v99
    v_add_f32 v112, v112, v100
    v_add_f32 v113, v113, v101
    v_add_f32 v112, v112, v102
    v_add_f32 v113, v113, v103
    v_add_f32 v112, v112, v104
    v_add_f32 v113, v113, v105
    v_add_f32 v112, v112, v106
    v_add_f32 v113, v113, v107
    v_add_f32 v112, v112, v108
    v_add_f32 v113, v113, v109
    v_add_f32 v112, v112, v110
    v_add_f32 v113, v113, v111
    v_add_f32 v112, v112, v113
    s_nop 1
    v_add_f32_dpp v112, v112, v112 row_ror:8 row_mask:0xf bank_mask:0xf
    s_nop 1
    v_add_f32_dpp v112, v112, v112 row_ror:4 row_mask:0xf bank_mask:0xf
    s_nop 1
    v_add_f32_dpp v112, v112, v112 row_ror:2 row_mask:0xf bank_mask:0xf
    s_nop 1
    v_add_f32_dpp v112, v112, v112 row_ror:1 row_mask:0xf bank_mask:0xf
    v_mov_b32 v113, v112
    s_nop 1
    v_permlane16_swap_b32 v112, v113
    v_add_f32 v112, v112, v113
    v_mul_f32 v112, 0x3b000000, v112
    v_sub_f32 v96, v96, v112
    v_sub_f32 v97, v97, v112
    v_sub_f32 v98, v98, v112
    v_sub_f32 v99, v99, v112
    v_sub_f32 v100, v100, v112
    v_sub_f32 v101, v101, v112
    v_sub_f32 v102, v102, v112
    v_sub_f32 v103, v103, v112
    v_sub_f32 v104, v104, v112
    v_sub_f32 v105, v105, v112
    v_sub_f32 v106, v106, v112
    v_sub_f32 v107, v107, v112
    v_sub_f32 v108, v108, v112
    v_sub_f32 v109, v109, v112
    v_sub_f32 v110, v110, v112
    v_sub_f32 v111, v111, v112
    v_mul_f32 v96, v96, v96
    v_mul_f32 v97, v97, v97
    v_mul_f32 v98, v98, v98
    v_mul_f32 v99, v99, v99
    v_mul_f32 v100, v100, v100
    v_mul_f32 v101, v101, v101
    v_mul_f32 v102, v102, v102
    v_mul_f32 v103, v103, v103
    v_mul_f32 v104, v104, v104
    v_mul_f32 v105, v105, v105
    v_mul_f32 v106, v106, v106
    v_mul_f32 v107, v107, v107
    v_mul_f32 v108, v108, v108
    v_mul_f32 v109, v109, v109
    v_mul_f32 v110, v110, v110
    v_mul_f32 v111, v111, v111
    v_add_f32 v114, v96, v97
    v_add_f32 v115, v98, v99
    v_add_f32 v114, v114, v100
    v_add_f32 v115, v115, v101
    v_add_f32 v114, v114, v102
    v_add_f32 v115, v115, v103
    v_add_f32 v114, v114, v104
    v_add_f32 v115, v115, v105
    v_add_f32 v114, v114, v106
    v_add_f32 v115, v115, v107
    v_add_f32 v114, v114, v108
    v_add_f32 v115, v115, v109
    v_add_f32 v114, v114, v110
    v_add_f32 v115, v115, v111
    v_add_f32 v114, v114, v115
    s_nop 1
    v_add_f32_dpp v114, v114, v114 row_ror:8 row_mask:0xf bank_mask:0xf
    s_nop 1
    v_add_f32_dpp v114, v114, v114 row_ror:4 row_mask:0xf bank_mask:0xf
    s_nop 1
    v_add_f32_dpp v114, v114, v114 row_ror:2 row_mask:0xf bank_mask:0xf
    s_nop 1
    v_add_f32_dpp v114, v114, v114 row_ror:1 row_mask:0xf bank_mask:0xf
    v_mov_b32 v115, v114
    s_nop 1
    v_permlane16_swap_b32 v114, v115
    v_add_f32 v114, v114, v115
    v_mov_b32 v115, 0x3727c5ac
    v_fmac_f32 v115, 0x3b000000, v114
    v_rsq_f32 v114, v115
    v_readfirstlane_b32 s32, v240
    s_nop 1
    s_mul_i32 s32, s32, 0x9E3779B1
    s_add_u32 s32, s32, 0x7F4A7C15
    v_mov_b32 v113, s32
    v_mov_b32 v115, s32
    s_xor_b32 s54, s42, 4096
    s_lshr_b32 s54, s54, 1
    s_lshl_b32 s60, s49, 5
    s_add_u32 s54, s54, s60
    s_add_u32 s54, s54, 65536
    v_lshrrev_b32 v58, 5, v1
    v_lshlrev_b32 v58, 4, v58
    v_and_b32 v59, 31, v1
    v_cmp_eq_u32 vcc, 0, v59
    s_nop 1
    s_and_saveexec_b64 s[58:59], vcc
    buffer_store_dwordx4 v[112:115], v58, s[16:19], s54 offen sc1
    s_add_u32 m0, s62, 65536
    s_mov_b64 exec, s[58:59]
    s_add_u32 s51, s3, 512
    s_and_b32 s51, s51, 0x380
    s_mul_i32 s51, s51, 1792
    buffer_load_dwordx4 v6, s[8:11], s51 offen offset:0  lds
    buffer_load_dwordx4 v7, s[8:11], s51 offen offset:1024  lds
    s_add_u32 m0, s62, 73600
    s_nop 0
    buffer_load_dwordx4 v6, s[8:11], s51 offen offset:128  lds
    buffer_load_dwordx4 v7, s[8:11], s51 offen offset:1152  lds
    s_add_u32 m0, s61, 126976
    s_nop 0
    buffer_load_dwordx4 v8, s[8:11], s51 offen  lds
    s_cmp_lg_u32 s33, 3
    s_cbranch_scc1 L_tw_1
    s_lshr_b32 s54, s2, 3
    v_min_u32 v117, 7, v1
    v_lshl_add_u32 v117, v117, 5, s54
    v_mul_u32_u24 v117, 57344, v117
    v_min_u32 v118, 1, v1
    v_lshl_add_u32 v118, v118, 5, s54
    v_lshlrev_b32 v120, 15, v118
    v_mul_u32_u24 v121, 28672, v118
    v_lshlrev_b32 v118, 14, v118
    buffer_load_dword v191, v117, s[16:19], 0 offen
    buffer_load_dword v191, v121, s[12:15], 0 offen
    buffer_load_dword v191, v118, s[20:23], 0 offen
    buffer_load_dword v191, v118, s[24:27], 0 offen
    buffer_load_dword v191, v120, s[28:31], 0 offen
L_tw_1:
    s_waitcnt vmcnt(6)
    s_barrier
    ds_read_b128 a[192:195], v9 offset:4096
    ds_read_b64_tr_b16 a[224:225], v13 offset:0
    ds_read_b64_tr_b16 a[226:227], v13 offset:512
    ds_read_b128 a[204:207], v156 offset:4096
    ds_read_b64_tr_b16 a[228:229], v14 offset:0
    ds_read_b64_tr_b16 a[230:231], v14 offset:512
    ds_read_b64_tr_b16 a[232:233], v17 offset:12288
    ds_read_b64_tr_b16 a[234:235], v17 offset:12544
    ds_read_b128 a[196:199], v10 offset:4096
    ds_read_b64_tr_b16 a[236:237], v13 offset:2048
    ds_read_b64_tr_b16 a[238:239], v13 offset:2560
    s_add_u32 m0, s56, 98304
    s_add_u32 s50, s3, 512
    s_and_b32 s50, s50, 0x380
    buffer_load_dwordx4 v2, s[4:7], s50 offen offset:0  lds
    buffer_load_dwordx4 v3, s[4:7], s50 offen offset:1024  lds
    s_waitcnt lgkmcnt(8)
    v_mfma_f32_32x32x16_bf16 v[64:79], a[224:227], a[192:195], 0
    buffer_load_dwordx4 v4, s[4:7], s50 offen offset:2048  lds
    ds_read_b128 a[208:211], v157 offset:4096
    s_waitcnt lgkmcnt(8)
    v_mfma_f32_32x32x16_bf16 v[80:95], a[224:227], a[204:207], 0
    buffer_load_dwordx4 v5, s[4:7], s50 offen offset:3072  lds
    ds_read_b64_tr_b16 a[216:217], v14 offset:2048
    ds_read_b64_tr_b16 a[218:219], v14 offset:2560
    s_waitcnt lgkmcnt(8)
    v_mfma_f32_32x32x16_bf16 v[96:111], a[228:231], a[192:195], 0
    ds_read_b64_tr_b16 v[48:49], v19 offset:0
    ds_read_b64_tr_b16 v[50:51], v19 offset:512
    ds_read_b64_tr_b16 v[52:53], v20 offset:0
    v_mfma_f32_32x32x16_bf16 v[112:127], a[228:231], a[204:207], 0
    ds_read_b64_tr_b16 a[220:221], v17 offset:13312
    ds_read_b64_tr_b16 a[222:223], v17 offset:13568
    ds_read_b64_tr_b16 v[54:55], v20 offset:512
    s_waitcnt lgkmcnt(12)
    s_add_u32 m0, s47, 0
    v_mfma_f32_32x32x16_bf16 v[128:143], a[232:235], a[192:195], 0
    s_add_u32 s50, s3, 128
    s_and_b32 s50, s50, 0x380
    buffer_load_dwordx4 v2, s[4:7], s50 offen offset:0  lds
    ds_read_b128 a[200:203], v11 offset:4096
    s_waitcnt lgkmcnt(10)
    v_mfma_f32_32x32x16_bf16 v[64:79], a[236:239], a[196:199], v[64:79]
    buffer_load_dwordx4 v3, s[4:7], s50 offen offset:1024  lds
    ds_read_b64_tr_b16 a[224:225], v13 offset:4096
    ds_read_b64_tr_b16 a[226:227], v13 offset:4608
    s_waitcnt lgkmcnt(11)
    v_mfma_f32_32x32x16_bf16 v[80:95], a[236:239], a[208:211], v[80:95]
    buffer_load_dwordx4 v4, s[4:7], s50 offen offset:2048  lds
    ds_read_b128 a[212:215], v158 offset:4096
    s_waitcnt lgkmcnt(10)
    v_mfma_f32_32x32x16_bf16 v[96:111], a[216:219], a[196:199], v[96:111]
    ds_read_b64_tr_b16 a[228:229], v14 offset:4096
    ds_read_b64_tr_b16 a[230:231], v14 offset:4608
    ds_read_b64_tr_b16 v[144:145], v19 offset:8192
    v_and_b32 v230, 7, v1
    v_cmp_gt_u32 vcc, 5, v230
    v_lshlrev_b32 v231, 4, v230
    s_nop 0
    v_cndmask_b32 v231, 0, v231, vcc
    s_lshl_b32 s59, s39, 6
    v_add_u32 v231, s59, v231
    s_cmp_eq_u32 s39, 0
    s_cselect_b32 s59, 5, 8
    v_mov_b32 v227, 0x200
    v_cmp_eq_u32 vcc, s59, v230
    s_nop 1
    v_cndmask_b32 v231, v231, v227, vcc
    v_lshrrev_b32 v230, 3, v1
    v_mul_u32_u24 v230, 16448, v230
    v_add_u32 v236, v230, v231
    s_lshl_b32 s58, s33, 9
    s_add_u32 s58, s58, s38
    s_mul_i32 s58, s58, 514
    s_and_b32 s58, s58, -16
    s_and_b32 s59, s33, 1
    s_lshl_b32 s59, s59, 12
    s_lshr_b32 s54, s33, 1
    s_lshl_b32 s54, s54, 14
    s_add_u32 s59, s59, s54
    s_add_u32 s59, s59, 139264
    v_mfma_f32_32x32x16_bf16 v[112:127], a[216:219], a[208:211], v[112:127]
    buffer_load_dwordx4 v5, s[4:7], s50 offen offset:3072  lds
    ds_read_b64_tr_b16 a[232:233], v17 offset:14336
    ds_read_b64_tr_b16 a[234:235], v17 offset:14592
    s_waitcnt lgkmcnt(10)
    v_mfma_f32_32x32x16_bf16 v[128:143], a[220:223], a[196:199], v[128:143]
    s_add_u32 m0, s62, 81920
    s_add_u32 s51, s3, 128
    s_and_b32 s51, s51, 0x380
    s_mul_i32 s51, s51, 1792
    buffer_load_dwordx4 v6, s[8:11], s51 offen offset:0  lds
    ds_read_b128 a[192:195], v12 offset:4096
    s_waitcnt lgkmcnt(7)
    v_mfma_f32_32x32x16_bf16 v[64:79], a[224:227], a[200:203], v[64:79]
    ds_read_b64_tr_b16 a[236:237], v13 offset:6144
    ds_read_b64_tr_b16 a[238:239], v13 offset:6656
    ds_read_b64_tr_b16 v[146:147], v19 offset:8704
    s_waitcnt lgkmcnt(9)
    v_mfma_f32_32x32x16_bf16 v[80:95], a[224:227], a[212:215], v[80:95]
    buffer_load_dwordx4 v7, s[8:11], s51 offen offset:1024  lds
    ds_read_b128 a[204:207], v159 offset:4096
    s_waitcnt lgkmcnt(8)
    s_add_u32 m0, s62, 89984
    v_mfma_f32_32x32x16_bf16 v[96:111], a[228:231], a[200:203], v[96:111]
    buffer_load_dwordx4 v6, s[8:11], s51 offen offset:128  lds
    ds_read_b64_tr_b16 v[148:149], v20 offset:8192
    ds_read_b64_tr_b16 v[150:151], v20 offset:8704
    ds_read_b64_tr_b16 v[152:153], v237 offset:12288
    ds_read_b64_tr_b16 v[154:155], v237 offset:12544
    v_mfma_f32_32x32x16_bf16 v[112:127], a[228:231], a[212:215], v[112:127]
    ds_read_b64_tr_b16 a[216:217], v14 offset:6144
    ds_read_b64_tr_b16 a[218:219], v14 offset:6656
    ds_read_b64_tr_b16 a[220:221], v17 offset:15360
    s_waitcnt lgkmcnt(12)
    v_mfma_f32_32x32x16_bf16 v[128:143], a[232:235], a[200:203], v[128:143]
    buffer_load_dwordx4 v7, s[8:11], s51 offen offset:1152  lds
    ds_read_b64_tr_b16 a[222:223], v17 offset:15616
    s_waitcnt lgkmcnt(10)
    s_add_u32 m0, s61, 135168
    v_mfma_f32_32x32x16_bf16 v[64:79], a[236:239], a[192:195], v[64:79]
    buffer_load_dwordx4 v8, s[8:11], s51 offen  lds
    s_waitcnt lgkmcnt(4)
    v_mfma_f32_4x4x4_16b_bf16 v[40:43], v[56:57], v[48:49], 0
    v_mfma_f32_4x4x4_16b_bf16 v[44:47], v[56:57], v[52:53], 0
    v_mfma_f32_4x4x4_16b_bf16 v[168:171], v[56:57], v[144:145], 0
    v_mfma_f32_4x4x4_16b_bf16 v[172:175], v[56:57], v[148:149], 0
    v_mfma_f32_4x4x4_16b_bf16 v[180:183], v[56:57], v[152:153], 0
    v_mfma_f32_4x4x4_16b_bf16 v[40:43], v[56:57], v[50:51], v[40:43]
    v_mfma_f32_4x4x4_16b_bf16 v[44:47], v[56:57], v[54:55], v[44:47]
    v_mfma_f32_4x4x4_16b_bf16 v[168:171], v[56:57], v[146:147], v[168:171]
    v_mfma_f32_4x4x4_16b_bf16 v[172:175], v[56:57], v[150:151], v[172:175]
    v_mfma_f32_4x4x4_16b_bf16 v[180:183], v[56:57], v[154:155], v[180:183]
    v_mfma_f32_32x32x16_bf16 v[80:95], a[236:239], a[204:207], v[80:95]
    s_waitcnt vmcnt(9)
    s_barrier
    ds_read_b128 a[196:199], v232
    ds_read_b64_tr_b16 a[224:225], v13 offset:16384
    s_mov_b32 s94, 0xd5560004
    s_mov_b32 s95, 0xfffaaa
    v_lshlrev_b32 v196, 1, v1
    s_waitcnt lgkmcnt(4)
    s_add_u32 m0, s47, 4096
    v_mfma_f32_32x32x16_bf16 v[96:111], a[216:219], a[192:195], v[96:111]
    s_add_u32 s50, s3, 640
    s_and_b32 s50, s50, 0x380
    buffer_load_dwordx4 v2, s[4:7], s50 offen offset:0  lds
    ds_read_b64_tr_b16 a[226:227], v13 offset:16896
    ds_read_b64_tr_b16 v[48:49], v19 offset:16384
    v_lshrrev_b64 v[200:201], v196, s[94:95]
    v_mfma_f32_32x32x16_bf16 v[112:127], a[216:219], a[204:207], v[112:127]
    ds_read_b128 a[208:211], v185
    ds_read_b64_tr_b16 a[228:229], v14 offset:16384
    v_add_u32 v200, s40, v200
    v_and_b32 v200, 3, v200
    v_mul_u32_u24 v204, 7, v200
    v_and_b32 v196, 15, v1
    v_lshlrev_b32 v196, 2, v196
    s_waitcnt lgkmcnt(6)
    v_mfma_f32_32x32x16_bf16 v[128:143], a[220:223], a[192:195], v[128:143]
    buffer_load_dwordx4 v3, s[4:7], s50 offen offset:1024  lds
    ds_read_b64_tr_b16 a[230:231], v14 offset:16896
    ds_read_b64_tr_b16 a[232:233], v17 offset:28672
    s_waitcnt lgkmcnt(5)
    v_mfma_f32_32x32x16_bf16 v[64:79], a[224:227], a[196:199], v[64:79]
    ds_read_b64_tr_b16 a[234:235], v17 offset:28928
    ds_read_b128 a[200:203], v233
    s_mov_b32 s94, 0x65432100
    s_mov_b32 s95, 0x6543210
    v_lshrrev_b64 v[200:201], v196, s[94:95]
    s_mov_b32 s94, 0x21654321
    s_mov_b32 s95, 0x6543
    s_waitcnt lgkmcnt(5)
    v_mfma_f32_32x32x16_bf16 v[80:95], a[224:227], a[208:211], v[80:95]
    buffer_load_dwordx4 v4, s[4:7], s50 offen offset:2048  lds
    ds_read_b64_tr_b16 a[236:237], v13 offset:18432
    ds_read_b64_tr_b16 a[238:239], v13 offset:18944
    s_waitcnt lgkmcnt(5)
    v_mfma_f32_32x32x16_bf16 v[96:111], a[228:231], a[196:199], v[96:111]
    ds_read_b128 a[212:215], v186
    ds_read_b64_tr_b16 a[216:217], v14 offset:18432
    v_lshrrev_b64 v[202:203], v196, s[94:95]
    v_cmp_le_u32 vcc, 16, v1
    s_nop 1
    v_cndmask_b32 v200, v200, v202, vcc
    v_and_b32 v200, 7, v200
    s_and_b32 s94, s2, 7
    v_mfma_f32_32x32x16_bf16 v[112:127], a[228:231], a[208:211], v[112:127]
    buffer_load_dwordx4 v5, s[4:7], s50 offen offset:3072  lds
    ds_read_b64_tr_b16 a[218:219], v14 offset:18944
    ds_read_b64_tr_b16 a[220:221], v17 offset:29696
    s_waitcnt lgkmcnt(7)
    v_mfma_f32_32x32x16_bf16 v[128:143], a[232:235], a[196:199], v[128:143]
    ds_read_b64_tr_b16 a[222:223], v17 offset:29952
    ds_read_b128 a[192:195], v234
    s_add_u32 s94, s94, s41
    v_add_u32 v196, s94, v200
    v_subrev_u32 v197, 14, v196
    v_min_u32 v196, v196, v197
    v_subrev_u32 v197, 7, v196
    s_waitcnt lgkmcnt(6)
    v_mfma_f32_32x32x16_bf16 v[64:79], a[236:239], a[200:203], v[64:79]
    s_add_u32 m0, s62, 102400
    s_add_u32 s51, s3, 640
    s_and_b32 s51, s51, 0x380
    s_mul_i32 s51, s51, 1792
    buffer_load_dwordx4 v6, s[8:11], s51 offen offset:0  lds
    ds_read_b64_tr_b16 a[224:225], v13 offset:20480
    ds_read_b64_tr_b16 a[226:227], v13 offset:20992
    v_min_u32 v196, v196, v197
    s_waitcnt lgkmcnt(7)
    v_mfma_f32_32x32x16_bf16 v[80:95], a[236:239], a[212:215], v[80:95]
    ds_read_b128 a[204:207], v187
    ds_read_b64_tr_b16 a[228:229], v14 offset:20480
    v_add_u32 v196, v196, v204
    s_mul_i32 s94, s33, 20
    s_lshl_b32 s95, s33, 3
    s_add_u32 s95, s95, 60
    s_waitcnt lgkmcnt(7)
    v_mfma_f32_32x32x16_bf16 v[96:111], a[216:219], a[200:203], v[96:111]
    buffer_load_dwordx4 v7, s[8:11], s51 offen offset:1024  lds
    ds_read_b64_tr_b16 a[230:231], v14 offset:20992
    ds_read_b64_tr_b16 v[50:51], v19 offset:16896
    v_mov_b32 v197, s94
    v_mfma_f32_32x32x16_bf16 v[112:127], a[216:219], a[212:215], v[112:127]
    ds_read_b64_tr_b16 a[232:233], v17 offset:30720
    ds_read_b64_tr_b16 a[234:235], v17 offset:30976
    ds_read_b64_tr_b16 v[52:53], v20 offset:16384
    v_cmp_le_u32 vcc, 20, v196
    v_mov_b32 v198, s95
    s_nop 0
    v_cndmask_b32 v197, v197, v198, vcc
    s_waitcnt lgkmcnt(10)
    s_add_u32 m0, s62, 118656
    v_mfma_f32_32x32x16_bf16 v[128:143], a[220:223], a[200:203], v[128:143]
    buffer_load_dwordx4 v6, s[8:11], s51 offen offset:128  lds
    ds_read_b64_tr_b16 v[54:55], v20 offset:16896
    ds_read_b64_tr_b16 v[144:145], v19 offset:24576
    ds_read_b64_tr_b16 v[146:147], v19 offset:25088
    ds_read_b64_tr_b16 v[148:149], v20 offset:24576
    ds_read_b64_tr_b16 v[150:151], v20 offset:25088
    ds_read_b64_tr_b16 v[152:153], v237 offset:28672
    ds_read_b64_tr_b16 v[154:155], v237 offset:28928
    v_add_lshl_u32 v196, v196, v197, 10
    s_waitcnt lgkmcnt(14)
    v_mfma_f32_32x32x16_bf16 v[64:79], a[224:227], a[192:195], v[64:79]
    ds_read_b128 a[196:199], v235
    ds_read_b64_tr_b16 a[236:237], v13 offset:22528
    v_readlane_b32 s64, v196, 0
    v_readlane_b32 s65, v196, 1
    v_readlane_b32 s66, v196, 2
    v_readlane_b32 s67, v196, 3
    s_waitcnt lgkmcnt(15)
    v_mfma_f32_32x32x16_bf16 v[80:95], a[224:227], a[204:207], v[80:95]
    buffer_load_dwordx4 v7, s[8:11], s51 offen offset:1152  lds
    ds_read_b64_tr_b16 a[238:239], v13 offset:23040
    v_readlane_b32 s68, v196, 4
    s_waitcnt lgkmcnt(14)
    v_mfma_f32_32x32x16_bf16 v[96:111], a[228:231], a[192:195], v[96:111]
    ds_read_b128 a[208:211], v188
    ds_read_b64_tr_b16 a[216:217], v14 offset:22528
    v_readlane_b32 s69, v196, 5
    v_readlane_b32 s70, v196, 6
    v_readlane_b32 s71, v196, 7
    v_readlane_b32 s72, v196, 8
    s_waitcnt lgkmcnt(5)
    v_mfma_f32_4x4x4_16b_bf16 v[40:43], v[56:57], v[48:49], v[40:43]
    v_mfma_f32_4x4x4_16b_bf16 v[44:47], v[56:57], v[52:53], v[44:47]
    v_mfma_f32_4x4x4_16b_bf16 v[168:171], v[56:57], v[144:145], v[168:171]
    v_mfma_f32_4x4x4_16b_bf16 v[172:175], v[56:57], v[148:149], v[172:175]
    v_mfma_f32_4x4x4_16b_bf16 v[180:183], v[56:57], v[152:153], v[180:183]
    v_mfma_f32_4x4x4_16b_bf16 v[40:43], v[56:57], v[50:51], v[40:43]
    v_mfma_f32_4x4x4_16b_bf16 v[44:47], v[56:57], v[54:55], v[44:47]
    v_mfma_f32_4x4x4_16b_bf16 v[168:171], v[56:57], v[146:147], v[168:171]
    v_mfma_f32_4x4x4_16b_bf16 v[172:175], v[56:57], v[150:151], v[172:175]
    v_mfma_f32_4x4x4_16b_bf16 v[180:183], v[56:57], v[154:155], v[180:183]
    s_add_u32 m0, s61, 151552
    v_mfma_f32_32x32x16_bf16 v[112:127], a[228:231], a[204:207], v[112:127]
    buffer_load_dwordx4 v8, s[8:11], s51 offen  lds
    ds_read_b64_tr_b16 a[218:219], v14 offset:23040
    ds_read_b64_tr_b16 a[220:221], v17 offset:31744
    v_readlane_b32 s73, v196, 9
    v_mfma_f32_32x32x16_bf16 v[128:143], a[232:235], a[192:195], v[128:143]
    ds_read_b64_tr_b16 a[222:223], v17 offset:32000
    v_readlane_b32 s74, v196, 10
    v_readlane_b32 s75, v196, 11
    v_readlane_b32 s76, v196, 12
    v_readlane_b32 s77, v196, 13
    v_readlane_b32 s78, v196, 14
    v_readlane_b32 s79, v196, 15
    s_waitcnt lgkmcnt(5)
    v_mfma_f32_32x32x16_bf16 v[64:79], a[236:239], a[196:199], v[64:79]
    v_readlane_b32 s80, v196, 16
    v_readlane_b32 s81, v196, 17
    v_readlane_b32 s82, v196, 18
    v_readlane_b32 s83, v196, 19
    v_readlane_b32 s84, v196, 20
    v_readlane_b32 s85, v196, 21
    v_readlane_b32 s86, v196, 22
    s_waitcnt lgkmcnt(4)
    v_mfma_f32_32x32x16_bf16 v[80:95], a[236:239], a[208:211], v[80:95]
    s_waitcnt vmcnt(9)
    s_barrier
    ds_read_b128 a[200:203], v9 offset:0
    ds_read_b64_tr_b16 a[224:225], v13 offset:32768
    v_readlane_b32 s87, v196, 23
    v_readlane_b32 s88, v196, 24
    v_readlane_b32 s89, v196, 25
    v_readlane_b32 s90, v196, 26
    s_lshl_b32 s60, s33, 2
    v_add_u32 v58, s60, v26
    ds_write_b32 v58, v40 offset:40960
    ds_write_b32 v58, v44 offset:41984
    ds_write_b32 v58, v168 offset:43008
    ds_write_b32 v58, v172 offset:44032
    ds_write_b32 v58, v180 offset:45056
    s_waitcnt lgkmcnt(9)
    s_add_u32 m0, s56, 98304
    v_mfma_f32_32x32x16_bf16 v[96:111], a[216:219], a[196:199], v[96:111]
    s_add_u32 s50, s3, 256
    s_and_b32 s50, s50, 0x380
    buffer_load_dwordx4 v2, s[4:7], s50 offen offset:0  lds
    ds_read_b64_tr_b16 a[226:227], v13 offset:33280
    v_readlane_b32 s91, v196, 27
    v_mfma_f32_32x32x16_bf16 v[112:127], a[216:219], a[208:211], v[112:127]
    ds_read_b128 a[212:215], v156 offset:0
    ds_read_b64_tr_b16 a[228:229], v14 offset:32768
    v_lshrrev_b32 v228, 3, v1
    v_and_b32 v229, 7, v1
    v_lshlrev_b32 v229, 4, v229
    v_lshl_add_u32 v228, v228, 10, v229
    s_waitcnt lgkmcnt(10)
    v_mfma_f32_32x32x16_bf16 v[128:143], a[220:223], a[196:199], v[128:143]
    buffer_load_dwordx4 v3, s[4:7], s50 offen offset:1024  lds
    ds_read_b64_tr_b16 a[230:231], v14 offset:33280
    ds_read_b64_tr_b16 a[232:233], v17 offset:36864
    v_and_b32 v229, 16, v1
    s_waitcnt lgkmcnt(4)
    v_mfma_f32_32x32x16_bf16 v[64:79], a[224:227], a[200:203], v[64:79]
    ds_read_b64_tr_b16 a[234:235], v17 offset:37120
    ds_read_b128 a[192:195], v10 offset:0
    v_lshlrev_b32 v229, 2, v229
    v_xor_b32 v238, v228, v229
    v_add_u32 v239, 7168, v238
    s_waitcnt lgkmcnt(5)
    v_mfma_f32_32x32x16_bf16 v[80:95], a[224:227], a[212:215], v[80:95]
    buffer_load_dwordx4 v4, s[4:7], s50 offen offset:2048  lds
    ds_read_b64_tr_b16 a[236:237], v13 offset:34816
    ds_read_b64_tr_b16 a[238:239], v13 offset:35328
    s_waitcnt lgkmcnt(5)
    v_mfma_f32_32x32x16_bf16 v[96:111], a[228:231], a[200:203], v[96:111]
    ds_read_b128 a[204:207], v157 offset:0
    ds_read_b64_tr_b16 a[216:217], v14 offset:34816
    v_and_b32 v230, 31, v1
    v_or_b32 v231, s39, v230
    v_cmp_eq_u32 vcc, 0, v231
    v_lshlrev_b32 v230, 1, v230
    v_mov_b32 v231, 80
    v_cndmask_b32 v230, v230, v231, vcc
    v_lshrrev_b32 v231, 5, v1
    v_lshl_add_u32 v230, v231, 9, v230
    s_lshl_b32 s54, s38, 1
    s_and_b32 s54, s54, 15
    s_add_u32 s54, s54, s59
    v_add_u32 v184, s54, v230
    v_mfma_f32_32x32x16_bf16 v[112:127], a[228:231], a[212:215], v[112:127]
    buffer_load_dwordx4 v5, s[4:7], s50 offen offset:3072  lds
    ds_read_b64_tr_b16 a[218:219], v14 offset:35328
    ds_read_b64_tr_b16 a[220:221], v17 offset:37888
    s_waitcnt lgkmcnt(7)
    v_mfma_f32_32x32x16_bf16 v[128:143], a[232:235], a[200:203], v[128:143]
    ds_read_b64_tr_b16 a[222:223], v17 offset:38144
    ds_read_b128 a[196:199], v11 offset:0
    s_waitcnt lgkmcnt(6)
    v_mfma_f32_32x32x16_bf16 v[64:79], a[236:239], a[192:195], v[64:79]
    s_add_u32 m0, s62, 49152
    s_add_u32 s51, s3, 256
    s_and_b32 s51, s51, 0x380
    s_mul_i32 s51, s51, 1792
    buffer_load_dwordx4 v6, s[8:11], s51 offen offset:0  lds
    ds_read_b64_tr_b16 a[224:225], v13 offset:36864
    ds_read_b64_tr_b16 a[226:227], v13 offset:37376
    s_waitcnt lgkmcnt(7)
    v_mfma_f32_32x32x16_bf16 v[80:95], a[236:239], a[204:207], v[80:95]
    ds_read_b128 a[208:211], v158 offset:0
    ds_read_b64_tr_b16 a[228:229], v14 offset:36864
    v_mov_b32 v240, 0
    v_mov_b32 v241, 0
    v_mov_b32 v242, 0
    v_mov_b32 v243, 0
    v_mov_b32 v244, 0
    s_waitcnt lgkmcnt(7)
    v_mfma_f32_32x32x16_bf16 v[96:111], a[216:219], a[192:195], v[96:111]
    buffer_load_dwordx4 v7, s[8:11], s51 offen offset:1024  lds
    ds_read_b64_tr_b16 a[230:231], v14 offset:37376
    v_mfma_f32_32x32x16_bf16 v[112:127], a[216:219], a[204:207], v[112:127]
    ds_read_b64_tr_b16 a[232:233], v17 offset:38912
    ds_read_b64_tr_b16 a[234:235], v17 offset:39168
    v_mov_b32 v245, 0
    v_mov_b32 v246, 0
    v_mov_b32 v247, 0
    v_mov_b32 v248, 0
    v_mov_b32 v249, 0
    s_waitcnt lgkmcnt(8)
    s_add_u32 m0, s62, 57216
    v_mfma_f32_32x32x16_bf16 v[128:143], a[220:223], a[192:195], v[128:143]
    buffer_load_dwordx4 v6, s[8:11], s51 offen offset:128  lds
    ds_read_b128 a[200:203], v12 offset:0
    v_mov_b32 v250, 0
    s_waitcnt lgkmcnt(6)
    v_mfma_f32_32x32x16_bf16 v[64:79], a[224:227], a[196:199], v[64:79]
    ds_read_b64_tr_b16 a[236:237], v13 offset:38912
    ds_read_b64_tr_b16 a[238:239], v13 offset:39424
    v_mov_b32 v251, 0
    v_mov_b32 v252, 0
    v_mov_b32 v253, 0
    v_mov_b32 v254, 0
    s_waitcnt lgkmcnt(7)
    v_mfma_f32_32x32x16_bf16 v[80:95], a[224:227], a[208:211], v[80:95]
    buffer_load_dwordx4 v7, s[8:11], s51 offen offset:1152  lds
    ds_read_b128 a[212:215], v159 offset:0
    v_mov_b32 v255, 0
    s_waitcnt lgkmcnt(6)
    v_mfma_f32_32x32x16_bf16 v[96:111], a[228:231], a[196:199], v[96:111]
    ds_read_b64_tr_b16 a[216:217], v14 offset:38912
    ds_read_b64_tr_b16 a[218:219], v14 offset:39424
    v_mov_b32 v34, 0
    v_mov_b32 v35, 0
    v_mov_b32 v38, 0
    v_mov_b32 v39, 0
    s_add_u32 m0, s61, 110592
    v_mfma_f32_32x32x16_bf16 v[112:127], a[228:231], a[208:211], v[112:127]
    buffer_load_dwordx4 v8, s[8:11], s51 offen  lds
    ds_read_b64_tr_b16 a[220:221], v17 offset:39936
    ds_read_b64_tr_b16 a[222:223], v17 offset:40192
    v_mov_b32 v162, 0
    s_waitcnt lgkmcnt(8)
    v_mfma_f32_32x32x16_bf16 v[128:143], a[232:235], a[196:199], v[128:143]
    v_mov_b32 v163, 0
    v_xor_b32 v223, v222, v214
    v_accvgpr_write_b32 a160, v222
    v_accvgpr_write_b32 a176, v223
    v_cos_f32 v218, v216
    s_waitcnt lgkmcnt(5)
    v_mfma_f32_32x32x16_bf16 v[64:79], a[236:239], a[200:203], v[64:79]
    v_sin_f32 v219, v216
    v_add_f32 v216, v216, v217
    v_cvt_pk_bf16_f32 v224, v220, -v221
    v_xor_b32 v225, v224, v214
    v_accvgpr_write_b32 a161, v224
    v_accvgpr_write_b32 a177, v225
    s_waitcnt lgkmcnt(4)
    v_mfma_f32_32x32x16_bf16 v[80:95], a[236:239], a[212:215], v[80:95]
    s_waitcnt vmcnt(9)
    s_barrier
    ds_read_b128 a[192:195], v9 offset:4096
    ds_read_b64_tr_b16 a[224:225], v15 offset:4096
    v_cos_f32 v220, v216
    v_sin_f32 v221, v216
    v_fmac_f32 v216, 0x40a00000, v217
    s_mov_b32 s60, s33
    s_lshl_b32 s60, s60, 10
    v_add_u32 v59, s60, v26
    ds_read_b128 v[48:51], v59 offset:40960
    s_mov_b32 s60, 4
    s_lshl_b32 s60, s60, 10
    v_add_u32 v60, s60, v26
    ds_read_b128 v[52:55], v60 offset:40960
    s_waitcnt lgkmcnt(6)
    s_add_u32 m0, s47, 0
    v_mfma_f32_32x32x16_bf16 v[96:111], a[216:219], a[200:203], v[96:111]
    s_add_u32 s50, s3, 768
    s_and_b32 s50, s50, 0x380
    buffer_load_dwordx4 v2, s[4:7], s50 offen offset:0  lds
    ds_read_b64_tr_b16 a[226:227], v15 offset:4608
    v_cvt_pk_bf16_f32 v222, v218, -v219
    v_mfma_f32_32x32x16_bf16 v[112:127], a[216:219], a[212:215], v[112:127]
    ds_read_b128 a[204:207], v156 offset:4096
    ds_read_b64_tr_b16 a[228:229], v16 offset:4096
    v_xor_b32 v223, v222, v214
    v_accvgpr_write_b32 a162, v222
    v_accvgpr_write_b32 a178, v223
    v_cos_f32 v218, v216
    s_waitcnt lgkmcnt(3)
    v_add_f32 v48, v48, v49
    v_add_f32 v50, v50, v51
    v_add_f32 v52, v52, v53
    v_add_f32 v54, v54, v55
    v_mfma_f32_32x32x16_bf16 v[128:143], a[220:223], a[200:203], v[128:143]
    buffer_load_dwordx4 v3, s[4:7], s50 offen offset:1024  lds
    ds_read_b64_tr_b16 a[230:231], v16 offset:4608
    ds_read_b64_tr_b16 a[232:233], v17 offset:53248
    v_add_f32 v48, v48, v50
    s_waitcnt lgkmcnt(4)
    v_mfma_f32_32x32x16_bf16 v[64:79], a[224:227], a[192:195], v[64:79]
    ds_read_b64_tr_b16 a[234:235], v17 offset:53504
    ds_read_b128 a[196:199], v10 offset:4096
    v_sin_f32 v219, v216
    v_add_f32 v216, v216, v217
    v_cvt_pk_bf16_f32 v224, v220, -v221
    v_mov_b32 v49, s32
    v_add_f32 v50, v52, v54
    v_mov_b32 v51, s32
    v_lshrrev_b32 v59, 1, v59
    s_waitcnt lgkmcnt(5)
    v_mfma_f32_32x32x16_bf16 v[80:95], a[224:227], a[204:207], v[80:95]
    buffer_load_dwordx4 v4, s[4:7], s50 offen offset:2048  lds
    ds_read_b64_tr_b16 a[236:237], v15 offset:6144
    ds_read_b64_tr_b16 a[238:239], v15 offset:6656
    v_xor_b32 v225, v224, v214
    v_lshrrev_b32 v60, 1, v60
    s_waitcnt lgkmcnt(5)
    v_mfma_f32_32x32x16_bf16 v[96:111], a[228:231], a[192:195], v[96:111]
    s_and_b32 s60, s34, 3
    s_lshl_b32 s60, s60, 10
    s_add_u32 s60, s60, s57
    buffer_store_dwordx4 v[48:51], v26, s[16:19], s60 offen sc1
    ds_read_b128 a[208:211], v157 offset:4096
    v_accvgpr_write_b32 a163, v224
    v_mfma_f32_32x32x16_bf16 v[112:127], a[228:231], a[204:207], v[112:127]
    buffer_load_dwordx4 v5, s[4:7], s50 offen offset:3072  lds
    ds_read_b64_tr_b16 a[216:217], v16 offset:6144
    ds_read_b64_tr_b16 a[218:219], v16 offset:6656
    s_waitcnt lgkmcnt(6)
    v_mfma_f32_32x32x16_bf16 v[128:143], a[232:235], a[192:195], v[128:143]
    ds_read_b64_tr_b16 a[220:221], v17 offset:54272
    ds_read_b64_tr_b16 a[222:223], v17 offset:54528
    v_accvgpr_write_b32 a179, v225
    v_cos_f32 v220, v216
    v_sin_f32 v221, v216
    s_waitcnt lgkmcnt(5)
    v_mfma_f32_32x32x16_bf16 v[64:79], a[236:239], a[196:199], v[64:79]
    s_add_u32 m0, s62, 65536
    s_add_u32 s51, s3, 768
    s_and_b32 s51, s51, 0x380
    s_mul_i32 s51, s51, 1792
    buffer_load_dwordx4 v6, s[8:11], s51 offen offset:0  lds
    ds_read_b128 a[200:203], v11 offset:4096
    s_waitcnt lgkmcnt(5)
    v_mfma_f32_32x32x16_bf16 v[80:95], a[236:239], a[208:211], v[80:95]
    ds_read_b64_tr_b16 a[224:225], v15 offset:8192
    ds_read_b64_tr_b16 a[226:227], v15 offset:8704
    v_add_f32 v216, v216, v217
    v_cvt_pk_bf16_f32 v222, v218, -v219
    v_xor_b32 v223, v222, v214
    v_accvgpr_write_b32 a164, v222
    v_accvgpr_write_b32 a180, v223
    s_waitcnt lgkmcnt(5)
    v_mfma_f32_32x32x16_bf16 v[96:111], a[216:219], a[196:199], v[96:111]
    buffer_load_dwordx4 v7, s[8:11], s51 offen offset:1024  lds
    ds_read_b128 a[212:215], v158 offset:4096
    v_mfma_f32_32x32x16_bf16 v[112:127], a[216:219], a[208:211], v[112:127]
    ds_read_b64_tr_b16 a[228:229], v16 offset:8192
    ds_read_b64_tr_b16 a[230:231], v16 offset:8704
    ds_read_b64_tr_b16 a[232:233], v17 offset:55296
    v_cos_f32 v218, v216
    v_sin_f32 v219, v216
    s_waitcnt lgkmcnt(7)
    s_add_u32 m0, s62, 73600
    v_mfma_f32_32x32x16_bf16 v[128:143], a[220:223], a[196:199], v[128:143]
    buffer_load_dwordx4 v6, s[8:11], s51 offen offset:128  lds
    ds_read_b64_tr_b16 a[234:235], v17 offset:55552
    s_waitcnt lgkmcnt(5)
    v_mfma_f32_32x32x16_bf16 v[64:79], a[224:227], a[200:203], v[64:79]
    ds_read_b128 a[192:195], v12 offset:4096
    ds_read_b64_tr_b16 a[236:237], v15 offset:10240
    v_add_f32 v216, v216, v217
    v_cvt_pk_bf16_f32 v224, v220, -v221
    v_xor_b32 v225, v224, v214
    v_accvgpr_write_b32 a165, v224
    v_accvgpr_write_b32 a181, v225
    s_waitcnt lgkmcnt(6)
    v_mfma_f32_32x32x16_bf16 v[80:95], a[224:227], a[212:215], v[80:95]
    buffer_load_dwordx4 v7, s[8:11], s51 offen offset:1152  lds
    ds_read_b64_tr_b16 a[238:239], v15 offset:10752
    s_waitcnt lgkmcnt(5)
    v_mfma_f32_32x32x16_bf16 v[96:111], a[228:231], a[200:203], v[96:111]
    ds_read_b128 a[204:207], v159 offset:4096
    ds_read_b64_tr_b16 a[216:217], v16 offset:10240
    v_cos_f32 v220, v216
    v_sin_f32 v221, v216
    v_fmac_f32 v216, 0x40a00000, v217
    s_add_u32 m0, s61, 126976
    v_mfma_f32_32x32x16_bf16 v[112:127], a[228:231], a[212:215], v[112:127]
    buffer_load_dwordx4 v8, s[8:11], s51 offen  lds
    ds_read_b64_tr_b16 a[218:219], v16 offset:10752
    ds_read_b64_tr_b16 a[220:221], v17 offset:56320
    v_cvt_pk_bf16_f32 v222, v218, -v219
    s_waitcnt lgkmcnt(7)
    v_mfma_f32_32x32x16_bf16 v[128:143], a[232:235], a[200:203], v[128:143]
    ds_read_b64_tr_b16 a[222:223], v17 offset:56576
    v_xor_b32 v223, v222, v214
    v_accvgpr_write_b32 a166, v222
    v_accvgpr_write_b32 a182, v223
    v_cos_f32 v218, v216
    s_waitcnt lgkmcnt(5)
    v_mfma_f32_32x32x16_bf16 v[64:79], a[236:239], a[192:195], v[64:79]
    s_mov_b32 m0, s59
    s_nop 0
    buffer_load_dwordx4 v236, s[20:23], s58 offen lds
    v_sin_f32 v219, v216
    s_waitcnt lgkmcnt(4)
    v_mfma_f32_32x32x16_bf16 v[80:95], a[236:239], a[204:207], v[80:95]
    s_waitcnt vmcnt(11)
    s_barrier
    s_add_u32 m0, s59, 2048
    s_nop 0
    buffer_load_dwordx4 v236, s[24:27], s58 offen lds
    ds_read_b128 a[196:199], v232
    s_waitcnt lgkmcnt(3)
    s_add_u32 m0, s47, 4096
    v_mfma_f32_32x32x16_bf16 v[96:111], a[216:219], a[192:195], v[96:111]
    s_add_u32 s50, s3, 384
    s_and_b32 s50, s50, 0x380
    buffer_load_dwordx4 v2, s[4:7], s50 offen offset:0  lds
    ds_read_b64_tr_b16 a[224:225], v13 offset:0
    ds_read_b64_tr_b16 a[226:227], v13 offset:512
    v_add_f32 v216, v216, v217
    v_mfma_f32_32x32x16_bf16 v[112:127], a[216:219], a[204:207], v[112:127]
    ds_read_b128 a[208:211], v185
    ds_read_b64_tr_b16 a[228:229], v14 offset:0
    v_cvt_pk_bf16_f32 v224, v220, -v221
    v_xor_b32 v225, v224, v214
    v_accvgpr_write_b32 a167, v224
    v_accvgpr_write_b32 a183, v225
    s_waitcnt lgkmcnt(5)
    v_mfma_f32_32x32x16_bf16 v[128:143], a[220:223], a[192:195], v[128:143]
    buffer_load_dwordx4 v3, s[4:7], s50 offen offset:1024  lds
    ds_read_b64_tr_b16 a[230:231], v14 offset:512
    ds_read_b64_tr_b16 a[232:233], v17 offset:12288
    s_waitcnt lgkmcnt(4)
    v_mfma_f32_32x32x16_bf16 v[64:79], a[224:227], a[196:199], v[64:79]
    ds_read_b64_tr_b16 a[234:235], v17 offset:12544
    ds_read_b128 a[200:203], v233
    v_cos_f32 v220, v216
    v_sin_f32 v221, v216
    v_add_f32 v216, v216, v217
    s_waitcnt lgkmcnt(5)
    v_mfma_f32_32x32x16_bf16 v[80:95], a[224:227], a[208:211], v[80:95]
    buffer_load_dwordx4 v4, s[4:7], s50 offen offset:2048  lds
    ds_read_b64_tr_b16 a[236:237], v13 offset:2048
    ds_read_b64_tr_b16 a[238:239], v13 offset:2560
    v_cvt_pk_bf16_f32 v222, v218, -v219
    s_waitcnt lgkmcnt(5)
    v_mfma_f32_32x32x16_bf16 v[96:111], a[228:231], a[196:199], v[96:111]
    ds_read_b128 a[212:215], v186
    ds_read_b64_tr_b16 a[216:217], v14 offset:2048
    v_xor_b32 v223, v222, v214
    v_accvgpr_write_b32 a168, v222
    v_accvgpr_write_b32 a184, v223
    v_cos_f32 v218, v216
    v_mfma_f32_32x32x16_bf16 v[112:127], a[228:231], a[208:211], v[112:127]
    buffer_load_dwordx4 v5, s[4:7], s50 offen offset:3072  lds
    ds_read_b64_tr_b16 a[218:219], v14 offset:2560
    ds_read_b64_tr_b16 a[220:221], v17 offset:13312
    s_waitcnt lgkmcnt(7)
    v_mfma_f32_32x32x16_bf16 v[128:143], a[232:235], a[196:199], v[128:143]
    ds_read_b64_tr_b16 a[222:223], v17 offset:13568
    ds_read_b128 a[192:195], v234
    v_sin_f32 v219, v216
    v_add_f32 v216, v216, v217
    v_cvt_pk_bf16_f32 v224, v220, -v221
    v_xor_b32 v225, v224, v214
    s_waitcnt lgkmcnt(6)
    v_mfma_f32_32x32x16_bf16 v[64:79], a[236:239], a[200:203], v[64:79]
    s_add_u32 m0, s62, 81920
    s_add_u32 s51, s3, 384
    s_and_b32 s51, s51, 0x380
    s_mul_i32 s51, s51, 1792
    buffer_load_dwordx4 v6, s[8:11], s51 offen offset:0  lds
    ds_read_b64_tr_b16 a[224:225], v13 offset:4096
    ds_read_b64_tr_b16 a[226:227], v13 offset:4608
    s_waitcnt lgkmcnt(7)
    v_mfma_f32_32x32x16_bf16 v[80:95], a[236:239], a[212:215], v[80:95]
    ds_read_b128 a[204:207], v187
    ds_read_b64_tr_b16 a[228:229], v14 offset:4096
    v_accvgpr_write_b32 a169, v224
    v_accvgpr_write_b32 a185, v225
    v_cos_f32 v220, v216
    s_waitcnt lgkmcnt(7)
    v_mfma_f32_32x32x16_bf16 v[96:111], a[216:219], a[200:203], v[96:111]
    buffer_load_dwordx4 v7, s[8:11], s51 offen offset:1024  lds
    ds_read_b64_tr_b16 a[230:231], v14 offset:4608
    v_sin_f32 v221, v216
    v_mfma_f32_32x32x16_bf16 v[112:127], a[216:219], a[212:215], v[112:127]
    ds_read_b64_tr_b16 a[232:233], v17 offset:14336
    ds_read_b64_tr_b16 a[234:235], v17 offset:14592
    v_fmac_f32 v216, 0x40a00000, v217
    v_cvt_pk_bf16_f32 v222, v218, -v219
    v_xor_b32 v223, v222, v214
    v_accvgpr_write_b32 a170, v222
    s_waitcnt lgkmcnt(8)
    s_add_u32 m0, s62, 89984
    v_mfma_f32_32x32x16_bf16 v[128:143], a[220:223], a[200:203], v[128:143]
    buffer_load_dwordx4 v6, s[8:11], s51 offen offset:128  lds
    ds_read_b128 a[196:199], v235
    v_accvgpr_write_b32 a186, v223
    s_waitcnt lgkmcnt(6)
    v_mfma_f32_32x32x16_bf16 v[64:79], a[224:227], a[192:195], v[64:79]
    ds_read_b64_tr_b16 a[236:237], v13 offset:6144
    ds_read_b64_tr_b16 a[238:239], v13 offset:6656
    v_cos_f32 v218, v216
    v_sin_f32 v219, v216
    s_waitcnt lgkmcnt(7)
    v_mfma_f32_32x32x16_bf16 v[80:95], a[224:227], a[204:207], v[80:95]
    buffer_load_dwordx4 v7, s[8:11], s51 offen offset:1152  lds
    ds_read_b128 a[208:211], v188
    v_add_f32 v216, v216, v217
    s_waitcnt lgkmcnt(6)
    v_mfma_f32_32x32x16_bf16 v[96:111], a[228:231], a[192:195], v[96:111]
    ds_read_b64_tr_b16 a[216:217], v14 offset:6144
    ds_read_b64_tr_b16 a[218:219], v14 offset:6656
    v_cvt_pk_bf16_f32 v224, v220, -v221
    v_xor_b32 v225, v224, v214
    v_accvgpr_write_b32 a171, v224
    v_accvgpr_write_b32 a187, v225
    s_add_u32 m0, s61, 135168
    v_mfma_f32_32x32x16_bf16 v[112:127], a[228:231], a[204:207], v[112:127]
    buffer_load_dwordx4 v8, s[8:11], s51 offen  lds
    ds_read_b64_tr_b16 a[220:221], v17 offset:15360
    ds_read_b64_tr_b16 a[222:223], v17 offset:15616
    s_waitcnt lgkmcnt(8)
    v_mfma_f32_32x32x16_bf16 v[128:143], a[232:235], a[192:195], v[128:143]
    v_cos_f32 v220, v216
    v_sin_f32 v221, v216
    v_add_f32 v216, v216, v217
    v_cvt_pk_bf16_f32 v222, v218, -v219
    v_xor_b32 v223, v222, v214
    v_accvgpr_write_b32 a172, v222
    s_waitcnt lgkmcnt(5)
    s_add_u32 m0, s59, 1024
    v_mfma_f32_32x32x16_bf16 v[64:79], a[236:239], a[196:199], v[64:79]
    s_add_u32 s58, s58, 131584
    buffer_load_dwordx4 v236, s[20:23], s58 offen lds
    v_accvgpr_write_b32 a188, v223
    s_waitcnt lgkmcnt(4)
    v_mfma_f32_32x32x16_bf16 v[80:95], a[236:239], a[208:211], v[80:95]
    s_waitcnt vmcnt(12)
    s_barrier
    s_add_u32 m0, s59, 3072
    s_nop 0
    buffer_load_dwordx4 v236, s[24:27], s58 offen lds
    ds_read_b128 a[200:203], v9 offset:0
    s_waitcnt lgkmcnt(3)
    s_add_u32 m0, s56, 98304
    v_mfma_f32_32x32x16_bf16 v[96:111], a[216:219], a[196:199], v[96:111]
    s_add_u32 s50, s3, 896
    s_and_b32 s50, s50, 0x380
    buffer_load_dwordx4 v2, s[4:7], s50 offen offset:0  lds
    ds_read_b64_tr_b16 a[224:225], v13 offset:16384
    ds_read_b64_tr_b16 a[226:227], v13 offset:16896
    v_cos_f32 v218, v216
    v_mfma_f32_32x32x16_bf16 v[112:127], a[216:219], a[208:211], v[112:127]
    ds_read_b128 a[212:215], v156 offset:0
    ds_read_b64_tr_b16 a[228:229], v14 offset:16384
    v_sin_f32 v219, v216
    v_add_f32 v216, v216, v217
    v_cvt_pk_bf16_f32 v224, v220, -v221
    s_waitcnt lgkmcnt(5)
    v_mfma_f32_32x32x16_bf16 v[128:143], a[220:223], a[196:199], v[128:143]
    buffer_load_dwordx4 v3, s[4:7], s50 offen offset:1024  lds
    ds_read_b64_tr_b16 a[230:231], v14 offset:16896
    ds_read_b64_tr_b16 a[232:233], v17 offset:28672
    s_waitcnt lgkmcnt(4)
    v_mfma_f32_32x32x16_bf16 v[64:79], a[224:227], a[200:203], v[64:79]
    ds_read_b64_tr_b16 a[234:235], v17 offset:28928
    ds_read_b128 a[192:195], v10 offset:0
    v_xor_b32 v225, v224, v214
    v_accvgpr_write_b32 a173, v224
    v_accvgpr_write_b32 a189, v225
    v_cos_f32 v220, v216
    s_waitcnt lgkmcnt(5)
    v_mfma_f32_32x32x16_bf16 v[80:95], a[224:227], a[212:215], v[80:95]
    buffer_load_dwordx4 v4, s[4:7], s50 offen offset:2048  lds
    ds_read_b64_tr_b16 a[236:237], v13 offset:18432
    ds_read_b64_tr_b16 a[238:239], v13 offset:18944
    s_waitcnt lgkmcnt(5)
    v_mfma_f32_32x32x16_bf16 v[96:111], a[228:231], a[200:203], v[96:111]
    ds_read_b128 a[204:207], v157 offset:0
    ds_read_b64_tr_b16 a[216:217], v14 offset:18432
    v_sin_f32 v221, v216
    v_cvt_pk_bf16_f32 v222, v218, -v219
    v_xor_b32 v223, v222, v214
    v_accvgpr_write_b32 a174, v222
    v_mfma_f32_32x32x16_bf16 v[112:127], a[228:231], a[212:215], v[112:127]
    buffer_load_dwordx4 v5, s[4:7], s50 offen offset:3072  lds
    ds_read_b64_tr_b16 a[218:219], v14 offset:18944
    ds_read_b64_tr_b16 a[220:221], v17 offset:29696
    s_waitcnt lgkmcnt(7)
    v_mfma_f32_32x32x16_bf16 v[128:143], a[232:235], a[200:203], v[128:143]
    ds_read_b64_tr_b16 a[222:223], v17 offset:29952
    ds_read_b128 a[196:199], v11 offset:0
    v_accvgpr_write_b32 a190, v223
    v_cvt_pk_bf16_f32 v224, v220, -v221
    v_xor_b32 v225, v224, v214
    v_accvgpr_write_b32 a175, v224
    v_accvgpr_write_b32 a191, v225
    s_waitcnt lgkmcnt(6)
    v_mfma_f32_32x32x16_bf16 v[64:79], a[236:239], a[192:195], v[64:79]
    s_add_u32 m0, s62, 102400
    s_add_u32 s51, s3, 896
    s_and_b32 s51, s51, 0x380
    s_mul_i32 s51, s51, 1792
    buffer_load_dwordx4 v6, s[8:11], s51 offen offset:0  lds
    ds_read_b64_tr_b16 a[224:225], v13 offset:20480
    ds_read_b64_tr_b16 a[226:227], v13 offset:20992
    s_waitcnt lgkmcnt(7)
    v_mfma_f32_32x32x16_bf16 v[80:95], a[236:239], a[204:207], v[80:95]
    ds_read_b128 a[208:211], v158 offset:0
    ds_read_b64_tr_b16 a[228:229], v14 offset:20480
    s_waitcnt lgkmcnt(7)
    v_mfma_f32_32x32x16_bf16 v[96:111], a[216:219], a[192:195], v[96:111]
    buffer_load_dwordx4 v7, s[8:11], s51 offen offset:1024  lds
    ds_read_b64_tr_b16 a[230:231], v14 offset:20992
    v_mfma_f32_32x32x16_bf16 v[112:127], a[216:219], a[204:207], v[112:127]
    ds_read_b64_tr_b16 a[232:233], v17 offset:30720
    ds_read_b64_tr_b16 a[234:235], v17 offset:30976
    s_waitcnt lgkmcnt(8)
    s_add_u32 m0, s62, 118656
    v_mfma_f32_32x32x16_bf16 v[128:143], a[220:223], a[192:195], v[128:143]
    buffer_load_dwordx4 v6, s[8:11], s51 offen offset:128  lds
    ds_read_b128 a[200:203], v12 offset:0
    s_waitcnt lgkmcnt(6)
    v_mfma_f32_32x32x16_bf16 v[64:79], a[224:227], a[196:199], v[64:79]
    ds_read_b64_tr_b16 a[236:237], v13 offset:22528
    ds_read_b64_tr_b16 a[238:239], v13 offset:23040
    s_lshr_b32 s63, s42, 1
    s_add_u32 s63, s63, 65536
    v_and_b32 v62, 31, v1
    v_lshlrev_b32 v62, 4, v62
    buffer_load_dwordx4 v[192:195], v62, s[16:19], s63 offen sc1
    s_xor_b32 s99, s63, 512
    buffer_load_dwordx4 v[212:215], v62, s[16:19], s99 offen sc1
    s_waitcnt lgkmcnt(7)
    v_mfma_f32_32x32x16_bf16 v[80:95], a[224:227], a[208:211], v[80:95]
    buffer_load_dwordx4 v7, s[8:11], s51 offen offset:1152  lds
    ds_read_b128 a[212:215], v159 offset:0
    s_waitcnt lgkmcnt(6)
    v_mfma_f32_32x32x16_bf16 v[96:111], a[228:231], a[196:199], v[96:111]
    buffer_load_dwordx4 v[196:199], v26, s[16:19], s57 offen offset:0 sc1
    ds_read_b64_tr_b16 a[216:217], v14 offset:22528
    ds_read_b64_tr_b16 a[218:219], v14 offset:23040
    s_add_u32 m0, s61, 151552
    v_mfma_f32_32x32x16_bf16 v[112:127], a[228:231], a[208:211], v[112:127]
    buffer_load_dwordx4 v8, s[8:11], s51 offen  lds
    buffer_load_dwordx4 v[200:203], v26, s[16:19], s57 offen offset:1024 sc1
    ds_read_b64_tr_b16 a[220:221], v17 offset:31744
    ds_read_b64_tr_b16 a[222:223], v17 offset:32000
    s_waitcnt lgkmcnt(8)
    v_mfma_f32_32x32x16_bf16 v[128:143], a[232:235], a[196:199], v[128:143]
    buffer_load_dwordx4 v[204:207], v26, s[16:19], s57 offen offset:2048 sc1
    s_waitcnt lgkmcnt(5)
    v_mfma_f32_32x32x16_bf16 v[64:79], a[236:239], a[200:203], v[64:79]
    buffer_load_dwordx4 v[208:211], v26, s[16:19], s57 offen offset:3072 sc1
    s_waitcnt lgkmcnt(4)
    v_mfma_f32_32x32x16_bf16 v[80:95], a[236:239], a[212:215], v[80:95]
    s_waitcnt vmcnt(17)
    s_barrier
    s_add_u32 m0, s47, 0
    s_lshl4_add_u32 s55, s79, s48
    buffer_load_dwordx4 v238, s[12:15], s55 offen lds
    ds_read_b128 a[192:195], v9 offset:4096
    s_waitcnt lgkmcnt(3)
    v_mfma_f32_32x32x16_bf16 v[96:111], a[216:219], a[200:203], v[96:111]
    ds_read_b64_tr_b16 a[224:225], v13 offset:32768
    ds_read_b64_tr_b16 a[226:227], v13 offset:33280
    v_mfma_f32_32x32x16_bf16 v[112:127], a[216:219], a[212:215], v[112:127]
    buffer_load_dwordx4 v239, s[12:15], s55 offen offset:1024 lds
    ds_read_b128 a[204:207], v156 offset:4096
    s_waitcnt lgkmcnt(4)
    v_mfma_f32_32x32x16_bf16 v[128:143], a[220:223], a[200:203], v[128:143]
    ds_read_b64_tr_b16 a[228:229], v14 offset:32768
    ds_read_b64_tr_b16 a[230:231], v14 offset:33280
    ds_read_b64_tr_b16 a[232:233], v17 offset:36864
    s_waitcnt lgkmcnt(4)
    s_add_u32 m0, s47, 2048
    v_mfma_f32_32x32x16_bf16 v[64:79], a[224:227], a[192:195], v[64:79]
    s_lshl4_add_u32 s55, s80, s48
    buffer_load_dwordx4 v238, s[12:15], s55 offen lds
    ds_read_b64_tr_b16 a[234:235], v17 offset:37120
    s_waitcnt lgkmcnt(4)
    v_mfma_f32_32x32x16_bf16 v[80:95], a[224:227], a[204:207], v[80:95]
    ds_read_b128 a[196:199], v10 offset:4096
    ds_read_b64_tr_b16 a[236:237], v13 offset:34816
    s_waitcnt lgkmcnt(4)
    v_mfma_f32_32x32x16_bf16 v[96:111], a[228:231], a[192:195], v[96:111]
    buffer_load_dwordx4 v239, s[12:15], s55 offen offset:1024 lds
    ds_read_b64_tr_b16 a[238:239], v13 offset:35328
    v_mfma_f32_32x32x16_bf16 v[112:127], a[228:231], a[204:207], v[112:127]
    ds_read_b128 a[208:211], v157 offset:4096
    ds_read_b64_tr_b16 a[216:217], v14 offset:34816
    s_waitcnt lgkmcnt(5)
    s_add_u32 m0, s62, 49152
    v_mfma_f32_32x32x16_bf16 v[128:143], a[232:235], a[192:195], v[128:143]
    s_lshl4_add_u32 s55, s83, s48
    buffer_load_dwordx4 v238, s[12:15], s55 offen lds
    ds_read_b64_tr_b16 a[218:219], v14 offset:35328
    ds_read_b64_tr_b16 a[220:221], v17 offset:37888
    s_waitcnt vmcnt(20)
    s_waitcnt lgkmcnt(4)
    v_mfma_f32_32x32x16_bf16 v[64:79], a[236:239], a[196:199], v[64:79]
    ds_read_b64_tr_b16 a[222:223], v17 offset:38144
    ds_read_b128 a[200:203], v11 offset:4096
    s_waitcnt lgkmcnt(5)
    v_mfma_f32_32x32x16_bf16 v[80:95], a[236:239], a[208:211], v[80:95]
    ds_read_b64_tr_b16 a[224:225], v13 offset:36864
    ds_read_b64_tr_b16 a[226:227], v13 offset:37376
    s_waitcnt vmcnt(11)
    v_xor_b32 v61, s32, v193
    v_xor_b32 v63, s32, v195
    v_bitop3_b32 v61, v213, s32, v61 bitop3:0xbe
    v_bitop3_b32 v63, v215, s32, v63 bitop3:0xbe
    v_or_b32 v61, v61, v63
    v_cmp_ne_u32 vcc, 0, v61
    s_nop 1
    s_cbranch_vccnz L_again_2
L_back_3:
    v_mul_f32 v23, 0xbfb8aa3b, v194
    v_rcp_f32 v24, v194
    v_cvt_pk_bf16_f32 v28, -v192, -v192
    v_mov_b32 v30, 0
    v_and_b32 v193, 0xffff0000, v28
    v_mov_b32 v31, 0
    v_sub_f32 v193, -v192, v193
    v_cvt_pk_bf16_f32 v29, v193, v30
    v_mul_f32 v189, 0xbfb8aa3b, v214
    v_rcp_f32 v190, v214
    v_cvt_pk_bf16_f32 v176, -v212, -v212
    v_mov_b32 v178, 0
    v_and_b32 v213, 0xffff0000, v176
    v_mov_b32 v179, 0
    v_sub_f32 v213, -v212, v213
    v_cvt_pk_bf16_f32 v177, v213, v178
    s_waitcnt lgkmcnt(5)
    v_mfma_f32_32x32x16_bf16 v[96:111], a[216:219], a[196:199], v[96:111]
    ds_read_b128 a[212:215], v158 offset:4096
    ds_read_b64_tr_b16 a[228:229], v14 offset:36864
    v_mfma_f32_32x32x16_bf16 v[112:127], a[216:219], a[208:211], v[112:127]
    buffer_load_dwordx4 v239, s[12:15], s55 offen offset:1024 lds
    ds_read_b64_tr_b16 a[230:231], v14 offset:37376
    ds_read_b64_tr_b16 a[232:233], v17 offset:38912
    s_waitcnt lgkmcnt(7)
    v_mfma_f32_32x32x16_bf16 v[128:143], a[220:223], a[196:199], v[128:143]
    ds_read_b64_tr_b16 a[234:235], v17 offset:39168
    ds_read_b128 a[192:195], v12 offset:4096
    s_waitcnt lgkmcnt(6)
    v_mfma_f32_32x32x16_bf16 v[64:79], a[224:227], a[200:203], v[64:79]
    ds_read_b64_tr_b16 a[236:237], v13 offset:38912
    ds_read_b64_tr_b16 a[238:239], v13 offset:39424
    ds_read_u16_d16_hi v240, v184 offset:0
    s_waitcnt lgkmcnt(8)
    v_mfma_f32_32x32x16_bf16 v[80:95], a[224:227], a[212:215], v[80:95]
    ds_read_b128 a[204:207], v159 offset:4096
    ds_read_b64_tr_b16 a[216:217], v14 offset:38912
    s_waitcnt lgkmcnt(8)
    s_add_u32 m0, s62, 57344
    v_mfma_f32_32x32x16_bf16 v[96:111], a[228:231], a[200:203], v[96:111]
    s_lshl4_add_u32 s55, s84, s48
    buffer_load_dwordx4 v238, s[12:15], s55 offen lds
    ds_read_b64_tr_b16 a[218:219], v14 offset:39424
    ds_read_u16_d16_hi v241, v184 offset:2048
    v_mfma_f32_32x32x16_bf16 v[112:127], a[228:231], a[212:215], v[112:127]
    ds_read_b64_tr_b16 a[220:221], v17 offset:39936
    ds_read_b64_tr_b16 a[222:223], v17 offset:40192
    ds_read_u16_d16_hi v242, v184 offset:128
    s_waitcnt lgkmcnt(11)
    v_mfma_f32_32x32x16_bf16 v[128:143], a[232:235], a[200:203], v[128:143]
    ds_read_u16_d16_hi v243, v184 offset:2176
    ds_read_u16_d16_hi v244, v184 offset:256
    ds_read_u16_d16_hi v245, v184 offset:2304
    s_waitcnt vmcnt(7)
    v_xor_b32 v61, s32, v197
    v_xor_b32 v63, s32, v199
    v_bitop3_b32 v61, v201, s32, v61 bitop3:0xbe
    v_bitop3_b32 v63, v203, s32, v63 bitop3:0xbe
    v_bitop3_b32 v61, v205, s32, v61 bitop3:0xbe
    v_bitop3_b32 v63, v207, s32, v63 bitop3:0xbe
    v_bitop3_b32 v61, v209, s32, v61 bitop3:0xbe
    v_bitop3_b32 v63, v211, s32, v63 bitop3:0xbe
    v_or_b32 v61, v61, v63
    v_cmp_ne_u32 vcc, 0, v61
    s_nop 1
    s_cbranch_vccnz L_again_5
L_back_6:
    s_waitcnt lgkmcnt(11)
    v_mfma_f32_32x32x16_bf16 v[64:79], a[236:239], a[192:195], v[64:79]
    ds_read_u16_d16_hi v246, v184 offset:384
    ds_read_u16_d16_hi v247, v184 offset:2432
    ds_read_u16_d16_hi v248, v184 offset:1024
    v_add_f32 v196, v196, v200
    v_add_f32 v198, v198, v202
    v_add_f32 v204, v204, v208
    s_waitcnt lgkmcnt(12)
    v_mfma_f32_32x32x16_bf16 v[80:95], a[236:239], a[204:207], v[80:95]
    s_barrier
    buffer_load_dwordx4 v239, s[12:15], s55 offen offset:1024 lds
    ds_read_b128 a[196:199], v232
    s_waitcnt lgkmcnt(11)
    v_mfma_f32_32x32x16_bf16 v[96:111], a[216:219], a[192:195], v[96:111]
    ds_read_b64_tr_b16 a[224:225], v15 offset:4096
    ds_read_b64_tr_b16 a[226:227], v15 offset:4608
    ds_read_u16_d16_hi v249, v184 offset:3072
    v_add_f32 v206, v206, v210
    v_add_f32 v196, v196, v204
    v_add_f32 v198, v198, v206
    v_mfma_f32_32x32x16_bf16 v[112:127], a[216:219], a[204:207], v[112:127]
    ds_read_b128 a[208:211], v185
    ds_read_b64_tr_b16 a[228:229], v16 offset:4096
    v_cvt_pk_bf16_f32 v201, v196, v196
    v_cvt_pk_bf16_f32 v203, v198, v198
    v_and_b32 v197, 0xffff0000, v201
    v_and_b32 v199, 0xffff0000, v203
    s_waitcnt lgkmcnt(13)
    v_mfma_f32_32x32x16_bf16 v[128:143], a[220:223], a[192:195], v[128:143]
    ds_read_b64_tr_b16 a[230:231], v16 offset:4608
    ds_read_b64_tr_b16 a[232:233], v17 offset:53248
    ds_read_b64_tr_b16 a[234:235], v17 offset:53504
    v_sub_f32 v204, v196, v197
    v_sub_f32 v206, v198, v199
    v_cvt_pk_bf16_f32 v200, v197, v204
    s_waitcnt lgkmcnt(6)
    s_add_u32 m0, s47, 4096
    v_mfma_f32_32x32x16_bf16 v[64:79], a[224:227], a[196:199], v[64:79]
    s_lshl4_add_u32 s55, s81, s48
    buffer_load_dwordx4 v238, s[12:15], s55 offen lds
    ds_read_b128 a[200:203], v233
    s_waitcnt lgkmcnt(5)
    v_mfma_f32_32x32x16_bf16 v[80:95], a[224:227], a[208:211], v[80:95]
    ds_read_b64_tr_b16 a[236:237], v15 offset:6144
    ds_read_b64_tr_b16 a[238:239], v15 offset:6656
    ds_read_u16_d16_hi v250, v184 offset:1152
    v_cvt_pk_bf16_f32 v202, v199, v206
    ds_write_b64 v59, v[200:201] offset:40960
    ds_write_b64 v60, v[202:203] offset:40960
    s_waitcnt lgkmcnt(8)
    v_mfma_f32_32x32x16_bf16 v[96:111], a[228:231], a[196:199], v[96:111]
    s_waitcnt lgkmcnt(0)
    s_barrier
    ds_read_b128 a[212:215], v186
    ds_read_b64_tr_b16 a[216:217], v16 offset:6144
    s_and_b32 s60, s33, 1
    s_lshl_b32 s60, s60, 10
    v_lshlrev_b32 v61, 3, v1
    v_add_u32 v63, s60, v61
    ds_read_b64 v[32:33], v63 offset:40960
    ds_read_b64 v[36:37], v63 offset:41472
    ds_read_b64 v[160:161], v61 offset:43008
    v_mfma_f32_32x32x16_bf16 v[112:127], a[228:231], a[208:211], v[112:127]
    buffer_load_dwordx4 v239, s[12:15], s55 offen offset:1024 lds
    ds_read_b64_tr_b16 a[218:219], v16 offset:6656
    ds_read_b64_tr_b16 a[220:221], v17 offset:54272
    v_mfma_f32_32x32x16_bf16 v[128:143], a[232:235], a[196:199], v[128:143]
    ds_read_b64_tr_b16 a[222:223], v17 offset:54528
    ds_read_b128 a[192:195], v234
    v_mfma_f32_32x32x16_bf16 v[64:79], a[236:239], a[200:203], v[64:79]
    ds_read_b64_tr_b16 a[224:225], v15 offset:8192
    ds_read_b64_tr_b16 a[226:227], v15 offset:8704
    ds_read_u16_d16_hi v251, v184 offset:3200
    s_waitcnt lgkmcnt(7)
    v_mfma_f32_32x32x16_bf16 v[64:79], v[32:35], v[28:31], v[64:79]
    s_add_u32 m0, s47, 6144
    v_mfma_f32_32x32x16_bf16 v[80:95], a[236:239], a[212:215], v[80:95]
    s_lshl4_add_u32 s55, s82, s48
    buffer_load_dwordx4 v238, s[12:15], s55 offen lds
    ds_read_u16_d16_hi v252, v184 offset:1280
    ds_read_u16_d16_hi v253, v184 offset:3328
    ds_read_u16_d16_hi v254, v184 offset:1408
    ds_read_u16_d16_hi v255, v184 offset:3456
    v_mfma_f32_32x32x16_bf16 v[80:95], v[32:35], v[176:179], v[80:95]
    s_waitcnt lgkmcnt(10)
    v_mfma_f32_32x32x16_bf16 v[96:111], a[216:219], a[200:203], v[96:111]
    ds_read_b128 a[204:207], v187
    ds_read_b64_tr_b16 a[228:229], v16 offset:8192
    v_mfma_f32_32x32x16_bf16 v[96:111], v[36:39], v[28:31], v[96:111]
    v_mfma_f32_32x32x16_bf16 v[112:127], a[216:219], a[212:215], v[112:127]
    ds_read_b64_tr_b16 a[230:231], v16 offset:8704
    ds_read_b64_tr_b16 a[232:233], v17 offset:55296
    ds_read_b64_tr_b16 a[234:235], v17 offset:55552
    v_mfma_f32_32x32x16_bf16 v[112:127], v[36:39], v[176:179], v[112:127]
    s_waitcnt lgkmcnt(13)
    v_mfma_f32_32x32x16_bf16 v[128:143], a[220:223], a[200:203], v[128:143]
    ds_read_b128 a[196:199], v235
    ds_read_b64_tr_b16 a[236:237], v15 offset:10240
    v_mfma_f32_32x32x16_bf16 v[128:143], v[160:163], v[28:31], v[128:143]
    s_waitcnt lgkmcnt(12)
    v_mfma_f32_32x32x16_bf16 v[64:79], a[224:227], a[192:195], v[64:79]
    buffer_load_dwordx4 v239, s[12:15], s55 offen offset:1024 lds
    ds_read_b64_tr_b16 a[238:239], v15 offset:10752
    s_waitcnt lgkmcnt(7)
    v_mfma_f32_32x32x16_bf16 v[80:95], a[224:227], a[204:207], v[80:95]
    ds_read_b128 a[208:211], v188
    ds_read_b64_tr_b16 a[216:217], v16 offset:10240
    s_waitcnt lgkmcnt(7)
    v_mfma_f32_32x32x16_bf16 v[96:111], a[228:231], a[192:195], v[96:111]
    ds_read_b64_tr_b16 a[218:219], v16 offset:10752
    s_add_u32 m0, s62, 65536
    v_mfma_f32_32x32x16_bf16 v[112:127], a[228:231], a[204:207], v[112:127]
    s_lshl4_add_u32 s55, s85, s48
    buffer_load_dwordx4 v238, s[12:15], s55 offen lds
    ds_read_b64_tr_b16 a[220:221], v17 offset:56320
    ds_read_b64_tr_b16 a[222:223], v17 offset:56576
    s_waitcnt lgkmcnt(8)
    v_mfma_f32_32x32x16_bf16 v[128:143], a[232:235], a[192:195], v[128:143]
    s_waitcnt lgkmcnt(5)
    v_mfma_f32_32x32x16_bf16 v[64:79], a[236:239], a[196:199], v[64:79]
    s_waitcnt lgkmcnt(4)
    v_mfma_f32_32x32x16_bf16 v[80:95], a[236:239], a[208:211], v[80:95]
    buffer_load_dwordx4 v239, s[12:15], s55 offen offset:1024 lds
    s_waitcnt lgkmcnt(2)
    v_mfma_f32_32x32x16_bf16 v[96:111], a[216:219], a[196:199], v[96:111]
    v_mfma_f32_32x32x16_bf16 v[112:127], a[216:219], a[208:211], v[112:127]
    s_waitcnt lgkmcnt(0)
    v_mfma_f32_32x32x16_bf16 v[128:143], a[220:223], a[196:199], v[128:143]
    s_barrier
    s_and_b32 s54, s33, 1
    s_lshl_b32 s53, s54, 12
    s_add_u32 s53, s53, s46
    s_mul_i32 s54, s54, 229376
    s_add_u32 s52, s53, 114688
    s_sub_u32 s52, s52, s54
    v_mov_b32 v58, v23
    v_mov_b32 v59, v23
    v_mov_b32 v60, v24
    v_mov_b32 v61, v24
    v_pk_mul_f32 v[192:193], v[64:65], v[58:59]
    v_pk_mul_f32 v[194:195], v[66:67], v[58:59]
    v_exp_f32 v192, v192
    v_exp_f32 v193, v193
    v_exp_f32 v194, v194
    v_exp_f32 v195, v195
    v_pk_fma_f32 v[192:193], v[192:193], v[60:61], v[60:61]
    v_pk_fma_f32 v[194:195], v[194:195], v[60:61], v[60:61]
    v_rcp_f32 v192, v192
    v_rcp_f32 v193, v193
    v_rcp_f32 v194, v194
    v_rcp_f32 v195, v195
    v_pk_mul_f32 v[192:193], v[192:193], v[64:65]
    v_pk_mul_f32 v[194:195], v[194:195], v[66:67]
    v_cvt_pk_bf16_f32 v200, v192, v193
    v_cvt_pk_bf16_f32 v201, v194, v195
    v_pk_mul_f32 v[196:197], v[68:69], v[58:59]
    v_pk_mul_f32 v[198:199], v[70:71], v[58:59]
    v_exp_f32 v196, v196
    v_exp_f32 v197, v197
    v_exp_f32 v198, v198
    v_exp_f32 v199, v199
    v_pk_fma_f32 v[196:197], v[196:197], v[60:61], v[60:61]
    v_pk_fma_f32 v[198:199], v[198:199], v[60:61], v[60:61]
    v_rcp_f32 v196, v196
    v_rcp_f32 v197, v197
    v_rcp_f32 v198, v198
    v_rcp_f32 v199, v199
    v_pk_mul_f32 v[196:197], v[196:197], v[68:69]
    v_pk_mul_f32 v[198:199], v[198:199], v[70:71]
    v_cvt_pk_bf16_f32 v202, v196, v197
    v_cvt_pk_bf16_f32 v203, v198, v199
    buffer_store_dwordx4 v[200:203], v26, s[16:19], s53 offen offset:0 sc1
    v_pk_mul_f32 v[192:193], v[72:73], v[58:59]
    v_pk_mul_f32 v[194:195], v[74:75], v[58:59]
    v_exp_f32 v192, v192
    v_exp_f32 v193, v193
    v_exp_f32 v194, v194
    v_exp_f32 v195, v195
    v_pk_fma_f32 v[192:193], v[192:193], v[60:61], v[60:61]
    v_pk_fma_f32 v[194:195], v[194:195], v[60:61], v[60:61]
    v_rcp_f32 v192, v192
    v_rcp_f32 v193, v193
    v_rcp_f32 v194, v194
    v_rcp_f32 v195, v195
    v_pk_mul_f32 v[192:193], v[192:193], v[72:73]
    v_pk_mul_f32 v[194:195], v[194:195], v[74:75]
    v_cvt_pk_bf16_f32 v204, v192, v193
    v_cvt_pk_bf16_f32 v205, v194, v195
    v_pk_mul_f32 v[196:197], v[76:77], v[58:59]
    v_pk_mul_f32 v[198:199], v[78:79], v[58:59]
    v_exp_f32 v196, v196
    v_exp_f32 v197, v197
    v_exp_f32 v198, v198
    v_exp_f32 v199, v199
    v_pk_fma_f32 v[196:197], v[196:197], v[60:61], v[60:61]
    v_pk_fma_f32 v[198:199], v[198:199], v[60:61], v[60:61]
    v_rcp_f32 v196, v196
    v_rcp_f32 v197, v197
    v_rcp_f32 v198, v198
    v_rcp_f32 v199, v199
    v_pk_mul_f32 v[196:197], v[196:197], v[76:77]
    v_pk_mul_f32 v[198:199], v[198:199], v[78:79]
    v_cvt_pk_bf16_f32 v206, v196, v197
    v_cvt_pk_bf16_f32 v207, v198, v199
    buffer_store_dwordx4 v[204:207], v26, s[16:19], s53 offen offset:1024 sc1
    v_pk_mul_f32 v[192:193], v[96:97], v[58:59]
    v_pk_mul_f32 v[194:195], v[98:99], v[58:59]
    v_exp_f32 v192, v192
    v_exp_f32 v193, v193
    v_exp_f32 v194, v194
    v_exp_f32 v195, v195
    v_pk_fma_f32 v[192:193], v[192:193], v[60:61], v[60:61]
    v_pk_fma_f32 v[194:195], v[194:195], v[60:61], v[60:61]
    v_rcp_f32 v192, v192
    v_rcp_f32 v193, v193
    v_rcp_f32 v194, v194
    v_rcp_f32 v195, v195
    v_pk_mul_f32 v[192:193], v[192:193], v[96:97]
    v_pk_mul_f32 v[194:195], v[194:195], v[98:99]
    v_cvt_pk_bf16_f32 v200, v192, v193
    v_cvt_pk_bf16_f32 v201, v194, v195
    v_pk_mul_f32 v[196:197], v[100:101], v[58:59]
    v_pk_mul_f32 v[198:199], v[102:103], v[58:59]
    v_exp_f32 v196, v196
    v_exp_f32 v197, v197
    v_exp_f32 v198, v198
    v_exp_f32 v199, v199
    v_pk_fma_f32 v[196:197], v[196:197], v[60:61], v[60:61]
    v_pk_fma_f32 v[198:199], v[198:199], v[60:61], v[60:61]
    v_rcp_f32 v196, v196
    v_rcp_f32 v197, v197
    v_rcp_f32 v198, v198
    v_rcp_f32 v199, v199
    v_pk_mul_f32 v[196:197], v[196:197], v[100:101]
    v_pk_mul_f32 v[198:199], v[198:199], v[102:103]
    v_cvt_pk_bf16_f32 v202, v196, v197
    v_cvt_pk_bf16_f32 v203, v198, v199
    buffer_store_dwordx4 v[200:203], v26, s[16:19], s53 offen offset:2048 sc1
    v_pk_mul_f32 v[192:193], v[104:105], v[58:59]
    v_pk_mul_f32 v[194:195], v[106:107], v[58:59]
    v_exp_f32 v192, v192
    v_exp_f32 v193, v193
    v_exp_f32 v194, v194
    s_lshr_b32 s60, s38, 1
    s_and_b32 s60, s60, 3
    s_lshl_b32 s60, s60, 8
    s_lshl_b32 s54, s39, 10
    s_add_u32 s60, s60, s54
    s_add_u32 s63, s60, 131072
    v_and_b32 v228, 15, v1
    v_lshlrev_b32 v228, 4, v228
    buffer_load_dword v229, v228, s[16:19], s63 offen sc1
    v_exp_f32 v195, v195
    v_pk_fma_f32 v[192:193], v[192:193], v[60:61], v[60:61]
    v_pk_fma_f32 v[194:195], v[194:195], v[60:61], v[60:61]
    v_rcp_f32 v192, v192
    v_rcp_f32 v193, v193
    v_rcp_f32 v194, v194
    v_rcp_f32 v195, v195
    v_pk_mul_f32 v[192:193], v[192:193], v[104:105]
    v_pk_mul_f32 v[194:195], v[194:195], v[106:107]
    v_cvt_pk_bf16_f32 v204, v192, v193
    v_cvt_pk_bf16_f32 v205, v194, v195
    v_pk_mul_f32 v[196:197], v[108:109], v[58:59]
    v_pk_mul_f32 v[198:199], v[110:111], v[58:59]
    v_exp_f32 v196, v196
    v_exp_f32 v197, v197
    v_exp_f32 v198, v198
    v_exp_f32 v199, v199
    v_pk_fma_f32 v[196:197], v[196:197], v[60:61], v[60:61]
    v_pk_fma_f32 v[198:199], v[198:199], v[60:61], v[60:61]
    v_rcp_f32 v196, v196
    v_rcp_f32 v197, v197
    v_rcp_f32 v198, v198
    v_rcp_f32 v199, v199
    v_pk_mul_f32 v[196:197], v[196:197], v[108:109]
    v_pk_mul_f32 v[198:199], v[198:199], v[110:111]
    v_cvt_pk_bf16_f32 v206, v196, v197
    v_cvt_pk_bf16_f32 v207, v198, v199
    buffer_store_dwordx4 v[204:207], v26, s[16:19], s53 offen offset:3072 sc1
    v_pk_mul_f32 v[192:193], v[128:129], v[58:59]
    v_pk_mul_f32 v[194:195], v[130:131], v[58:59]
    v_exp_f32 v192, v192
    v_exp_f32 v193, v193
    v_exp_f32 v194, v194
    s_add_u32 m0, s62, 73728
    s_lshl4_add_u32 s55, s76, s48
    buffer_load_dwordx4 v238, s[12:15], s55 offen lds
    v_exp_f32 v195, v195
    v_pk_fma_f32 v[192:193], v[192:193], v[60:61], v[60:61]
    v_pk_fma_f32 v[194:195], v[194:195], v[60:61], v[60:61]
    v_rcp_f32 v192, v192
    v_rcp_f32 v193, v193
    v_rcp_f32 v194, v194
    v_rcp_f32 v195, v195
    v_pk_mul_f32 v[192:193], v[192:193], v[128:129]
    v_pk_mul_f32 v[194:195], v[194:195], v[130:131]
    v_cvt_pk_bf16_f32 v200, v192, v193
    v_cvt_pk_bf16_f32 v201, v194, v195
    v_pk_mul_f32 v[196:197], v[132:133], v[58:59]
    v_pk_mul_f32 v[198:199], v[134:135], v[58:59]
    v_exp_f32 v196, v196
    v_exp_f32 v197, v197
    v_exp_f32 v198, v198
    v_exp_f32 v199, v199
    v_pk_fma_f32 v[196:197], v[196:197], v[60:61], v[60:61]
    v_pk_fma_f32 v[198:199], v[198:199], v[60:61], v[60:61]
    v_rcp_f32 v196, v196
    v_rcp_f32 v197, v197
    v_rcp_f32 v198, v198
    v_rcp_f32 v199, v199
    v_pk_mul_f32 v[196:197], v[196:197], v[132:133]
    v_pk_mul_f32 v[198:199], v[198:199], v[134:135]
    v_cvt_pk_bf16_f32 v202, v196, v197
    v_cvt_pk_bf16_f32 v203, v198, v199
    buffer_store_dwordx4 v[200:203], v26, s[16:19], s45 offen offset:0 sc1
    v_pk_mul_f32 v[192:193], v[136:137], v[58:59]
    v_pk_mul_f32 v[194:195], v[138:139], v[58:59]
    v_exp_f32 v192, v192
    v_exp_f32 v193, v193
    v_exp_f32 v194, v194
    v_exp_f32 v195, v195
    v_pk_fma_f32 v[192:193], v[192:193], v[60:61], v[60:61]
    v_pk_fma_f32 v[194:195], v[194:195], v[60:61], v[60:61]
    v_rcp_f32 v192, v192
    v_rcp_f32 v193, v193
    v_rcp_f32 v194, v194
    buffer_load_dwordx4 v239, s[12:15], s55 offen offset:1024 lds
    v_rcp_f32 v195, v195
    v_pk_mul_f32 v[192:193], v[192:193], v[136:137]
    v_pk_mul_f32 v[194:195], v[194:195], v[138:139]
    v_cvt_pk_bf16_f32 v204, v192, v193
    v_cvt_pk_bf16_f32 v205, v194, v195
    v_pk_mul_f32 v[196:197], v[140:141], v[58:59]
    v_pk_mul_f32 v[198:199], v[142:143], v[58:59]
    v_exp_f32 v196, v196
    v_exp_f32 v197, v197
    v_exp_f32 v198, v198
    v_exp_f32 v199, v199
    v_pk_fma_f32 v[196:197], v[196:197], v[60:61], v[60:61]
    v_pk_fma_f32 v[198:199], v[198:199], v[60:61], v[60:61]
    v_rcp_f32 v196, v196
    v_rcp_f32 v197, v197
    v_rcp_f32 v198, v198
    v_rcp_f32 v199, v199
    v_pk_mul_f32 v[196:197], v[196:197], v[140:141]
    v_pk_mul_f32 v[198:199], v[198:199], v[142:143]
    v_cvt_pk_bf16_f32 v206, v196, v197
    v_cvt_pk_bf16_f32 v207, v198, v199
    buffer_store_dwordx4 v[204:207], v26, s[16:19], s45 offen offset:1024 sc1
    v_mov_b32 v58, v189
    v_mov_b32 v59, v189
    v_mov_b32 v60, v190
    v_mov_b32 v61, v190
    v_pk_mul_f32 v[192:193], v[80:81], v[58:59]
    v_pk_mul_f32 v[194:195], v[82:83], v[58:59]
    v_exp_f32 v192, v192
    v_exp_f32 v193, v193
    v_exp_f32 v194, v194
    v_exp_f32 v195, v195
    v_pk_fma_f32 v[192:193], v[192:193], v[60:61], v[60:61]
    v_pk_fma_f32 v[194:195], v[194:195], v[60:61], v[60:61]
    v_rcp_f32 v192, v192
    v_rcp_f32 v193, v193
    v_rcp_f32 v194, v194
    v_rcp_f32 v195, v195
    v_pk_mul_f32 v[192:193], v[192:193], v[80:81]
    v_pk_mul_f32 v[194:195], v[194:195], v[82:83]
    s_add_u32 m0, s62, 81920
    s_lshl4_add_u32 s55, s77, s48
    buffer_load_dwordx4 v238, s[12:15], s55 offen lds
    v_cvt_pk_bf16_f32 v200, v192, v193
    v_cvt_pk_bf16_f32 v201, v194, v195
    v_pk_mul_f32 v[196:197], v[84:85], v[58:59]
    v_pk_mul_f32 v[198:199], v[86:87], v[58:59]
    v_exp_f32 v196, v196
    v_exp_f32 v197, v197
    v_exp_f32 v198, v198
    v_exp_f32 v199, v199
    v_pk_fma_f32 v[196:197], v[196:197], v[60:61], v[60:61]
    v_pk_fma_f32 v[198:199], v[198:199], v[60:61], v[60:61]
    v_rcp_f32 v196, v196
    v_rcp_f32 v197, v197
    v_rcp_f32 v198, v198
    v_rcp_f32 v199, v199
    v_pk_mul_f32 v[196:197], v[196:197], v[84:85]
    v_pk_mul_f32 v[198:199], v[198:199], v[86:87]
    v_cvt_pk_bf16_f32 v202, v196, v197
    v_cvt_pk_bf16_f32 v203, v198, v199
    buffer_store_dwordx4 v[200:203], v26, s[16:19], s52 offen offset:0 sc1
    v_pk_mul_f32 v[192:193], v[88:89], v[58:59]
    v_pk_mul_f32 v[194:195], v[90:91], v[58:59]
    v_exp_f32 v192, v192
    v_exp_f32 v193, v193
    v_exp_f32 v194, v194
    v_exp_f32 v195, v195
    v_pk_fma_f32 v[192:193], v[192:193], v[60:61], v[60:61]
    v_pk_fma_f32 v[194:195], v[194:195], v[60:61], v[60:61]
    v_rcp_f32 v192, v192
    v_rcp_f32 v193, v193
    v_rcp_f32 v194, v194
    v_rcp_f32 v195, v195
    s_waitcnt vmcnt(7)
    v_cmp_ne_u32 vcc, s32, v229
    s_nop 1
    s_cbranch_vccnz L_again_8
L_back_9:
    s_add_u32 m0, s62, 32768
    s_lshl_b32 s60, s39, 5
    s_add_u32 s60, s60, s38
    s_lshl_b32 s60, s60, 13
    s_add_u32 s60, s60, s62
    s_add_u32 s60, s60, 1048576
    buffer_load_dwordx4 v26, s[16:19], s60 offen offset:0 sc1 lds
    buffer_load_dwordx4 v26, s[16:19], s60 offen offset:1024 sc1 lds
    v_pk_mul_f32 v[192:193], v[192:193], v[88:89]
    v_pk_mul_f32 v[194:195], v[194:195], v[90:91]
    v_cvt_pk_bf16_f32 v204, v192, v193
    v_cvt_pk_bf16_f32 v205, v194, v195
    v_pk_mul_f32 v[196:197], v[92:93], v[58:59]
    v_pk_mul_f32 v[198:199], v[94:95], v[58:59]
    v_exp_f32 v196, v196
    v_exp_f32 v197, v197
    s_add_u32 m0, s62, 81920
    s_nop 0
    buffer_load_dwordx4 v239, s[12:15], s55 offen offset:1024 lds
    v_exp_f32 v198, v198
    v_exp_f32 v199, v199
    v_pk_fma_f32 v[196:197], v[196:197], v[60:61], v[60:61]
    v_pk_fma_f32 v[198:199], v[198:199], v[60:61], v[60:61]
    v_rcp_f32 v196, v196
    v_rcp_f32 v197, v197
    v_rcp_f32 v198, v198
    v_rcp_f32 v199, v199
    v_pk_mul_f32 v[196:197], v[196:197], v[92:93]
    v_pk_mul_f32 v[198:199], v[198:199], v[94:95]
    v_cvt_pk_bf16_f32 v206, v196, v197
    v_cvt_pk_bf16_f32 v207, v198, v199
    buffer_store_dwordx4 v[204:207], v26, s[16:19], s52 offen offset:1024 sc1
    v_pk_mul_f32 v[192:193], v[112:113], v[58:59]
    v_pk_mul_f32 v[194:195], v[114:115], v[58:59]
    v_exp_f32 v192, v192
    v_exp_f32 v193, v193
    v_exp_f32 v194, v194
    v_exp_f32 v195, v195
    v_pk_fma_f32 v[192:193], v[192:193], v[60:61], v[60:61]
    v_pk_fma_f32 v[194:195], v[194:195], v[60:61], v[60:61]
    v_rcp_f32 v192, v192
    v_rcp_f32 v193, v193
    v_rcp_f32 v194, v194
    v_rcp_f32 v195, v195
    v_pk_mul_f32 v[192:193], v[192:193], v[112:113]
    v_pk_mul_f32 v[194:195], v[194:195], v[114:115]
    v_cvt_pk_bf16_f32 v200, v192, v193
    v_cvt_pk_bf16_f32 v201, v194, v195
    v_pk_mul_f32 v[196:197], v[116:117], v[58:59]
    v_pk_mul_f32 v[198:199], v[118:119], v[58:59]
    v_exp_f32 v196, v196
    v_exp_f32 v197, v197
    v_exp_f32 v198, v198
    v_exp_f32 v199, v199
    v_pk_fma_f32 v[196:197], v[196:197], v[60:61], v[60:61]
    v_pk_fma_f32 v[198:199], v[198:199], v[60:61], v[60:61]
    v_rcp_f32 v196, v196
    v_rcp_f32 v197, v197
    v_rcp_f32 v198, v198
    s_add_u32 m0, s62, 90112
    s_lshl4_add_u32 s55, s78, s48
    buffer_load_dwordx4 v238, s[12:15], s55 offen lds
    v_rcp_f32 v199, v199
    v_pk_mul_f32 v[196:197], v[196:197], v[116:117]
    v_pk_mul_f32 v[198:199], v[198:199], v[118:119]
    v_cvt_pk_bf16_f32 v202, v196, v197
    v_cvt_pk_bf16_f32 v203, v198, v199
    buffer_store_dwordx4 v[200:203], v26, s[16:19], s52 offen offset:2048 sc1
    v_pk_mul_f32 v[192:193], v[120:121], v[58:59]
    v_pk_mul_f32 v[194:195], v[122:123], v[58:59]
    v_exp_f32 v192, v192
    v_exp_f32 v193, v193
    v_exp_f32 v194, v194
    v_exp_f32 v195, v195
    v_pk_fma_f32 v[192:193], v[192:193], v[60:61], v[60:61]
    v_pk_fma_f32 v[194:195], v[194:195], v[60:61], v[60:61]
    v_rcp_f32 v192, v192
    v_rcp_f32 v193, v193
    v_rcp_f32 v194, v194
    v_rcp_f32 v195, v195
    v_pk_mul_f32 v[192:193], v[192:193], v[120:121]
    v_pk_mul_f32 v[194:195], v[194:195], v[122:123]
    v_cvt_pk_bf16_f32 v204, v192, v193
    v_cvt_pk_bf16_f32 v205, v194, v195
    v_pk_mul_f32 v[196:197], v[124:125], v[58:59]
    v_pk_mul_f32 v[198:199], v[126:127], v[58:59]
    v_exp_f32 v196, v196
    v_exp_f32 v197, v197
    v_exp_f32 v198, v198
    v_exp_f32 v199, v199
    v_pk_fma_f32 v[196:197], v[196:197], v[60:61], v[60:61]
    v_pk_fma_f32 v[198:199], v[198:199], v[60:61], v[60:61]
    v_rcp_f32 v196, v196
    v_rcp_f32 v197, v197
    v_rcp_f32 v198, v198
    v_rcp_f32 v199, v199
    v_pk_mul_f32 v[196:197], v[196:197], v[124:125]
    v_pk_mul_f32 v[198:199], v[198:199], v[126:127]
    v_cvt_pk_bf16_f32 v206, v196, v197
    v_cvt_pk_bf16_f32 v207, v198, v199
    buffer_store_dwordx4 v[204:207], v26, s[16:19], s52 offen offset:3072 sc1
    buffer_load_dwordx4 v239, s[12:15], s55 offen offset:1024 lds
    v_lshrrev_b32 v62, 5, v1
    v_bfe_u32 v61, v1, 2, 2
    v_lshl_add_u32 v61, v62, 2, v61
    v_and_b32 v63, 3, v1
    v_lshlrev_b32 v63, 3, v63
    v_and_b32 v62, 16, v1
    v_lshl_add_u32 v63, v62, 1, v63
    v_lshl_add_u32 v63, v61, 7, v63
    v_and_b32 v62, 8, v1
    v_lshl_add_u32 v63, v62, 3, v63
    s_add_u32 s97, s47, 0
    v_add_u32 v9, s97, v63
    v_xor_b32 v10, 64, v9
    s_add_u32 s97, s62, 49152
    v_add_u32 v11, s97, v63
    v_xor_b32 v12, 64, v11
    s_add_u32 s97, s56, 98304
    v_add_u32 v13, s97, v63
    v_xor_b32 v14, 64, v13
    s_waitcnt vmcnt(6)
    s_barrier
    ds_read_b128 a[192:195], v26 offset:32768
    ds_read_b128 a[196:199], v26 offset:33792
    ds_read_b128 a[200:203], v26 offset:34816
    ds_read_b128 a[204:207], v26 offset:35840
    ds_read_b128 a[208:211], v26 offset:36864
    ds_read_b128 a[212:215], v26 offset:37888
    ds_read_b128 a[216:219], v26 offset:38912
    ds_read_b128 a[220:223], v26 offset:39936
    s_waitcnt lgkmcnt(7)
    s_add_u32 m0, s56, 98304
    v_mfma_f32_32x32x16_bf16 v[64:79], a[128:131], a[192:195], 0
    s_lshl4_add_u32 s55, s64, s48
    buffer_load_dwordx4 v238, s[12:15], s55 offen lds
    s_waitcnt lgkmcnt(6)
    v_mfma_f32_32x32x16_bf16 v[64:79], a[132:135], a[196:199], v[64:79]
    buffer_load_dwordx4 v239, s[12:15], s55 offen offset:1024 lds
    s_waitcnt lgkmcnt(5)
    s_add_u32 m0, s56, 100352
    v_mfma_f32_32x32x16_bf16 v[64:79], a[136:139], a[200:203], v[64:79]
    s_lshl4_add_u32 s55, s65, s48
    buffer_load_dwordx4 v238, s[12:15], s55 offen lds
    s_waitcnt lgkmcnt(4)
    v_mfma_f32_32x32x16_bf16 v[64:79], a[140:143], a[204:207], v[64:79]
    buffer_load_dwordx4 v239, s[12:15], s55 offen offset:1024 lds
    s_waitcnt lgkmcnt(3)
    s_add_u32 m0, s56, 102400
    v_mfma_f32_32x32x16_bf16 v[64:79], a[144:147], a[208:211], v[64:79]
    s_lshl4_add_u32 s55, s66, s48
    buffer_load_dwordx4 v238, s[12:15], s55 offen lds
    ds_read_b64_tr_b16 a[24:25], v9 offset:0
    ds_read_b64_tr_b16 a[26:27], v9 offset:1024
    ds_read_b64_tr_b16 a[28:29], v10 offset:0
    ds_read_b64_tr_b16 a[30:31], v10 offset:1024
    s_waitcnt lgkmcnt(6)
    v_mfma_f32_32x32x16_bf16 v[64:79], a[148:151], a[212:215], v[64:79]
    buffer_load_dwordx4 v239, s[12:15], s55 offen offset:1024 lds
    ds_read_b64_tr_b16 a[32:33], v9 offset:2048
    ds_read_b64_tr_b16 a[34:35], v9 offset:3072
    ds_read_b64_tr_b16 a[36:37], v10 offset:2048
    ds_read_b64_tr_b16 a[38:39], v10 offset:3072
    s_waitcnt lgkmcnt(9)
    s_add_u32 m0, s56, 104448
    v_mfma_f32_32x32x16_bf16 v[64:79], a[152:155], a[216:219], v[64:79]
    s_lshl4_add_u32 s55, s67, s48
    buffer_load_dwordx4 v238, s[12:15], s55 offen lds
    ds_read_b64_tr_b16 a[40:41], v9 offset:4096
    ds_read_b64_tr_b16 a[42:43], v9 offset:5120
    ds_read_b64_tr_b16 a[44:45], v10 offset:4096
    ds_read_b64_tr_b16 a[46:47], v10 offset:5120
    s_waitcnt lgkmcnt(12)
    v_mfma_f32_32x32x16_bf16 v[64:79], a[156:159], a[220:223], v[64:79]
    buffer_load_dwordx4 v239, s[12:15], s55 offen offset:1024 lds
    ds_read_b64_tr_b16 a[48:49], v9 offset:6144
    ds_read_b64_tr_b16 a[50:51], v9 offset:7168
    ds_read_b64_tr_b16 a[52:53], v10 offset:6144
    ds_read_b64_tr_b16 a[54:55], v10 offset:7168
    s_lshl_b32 s50, s34, 1
    s_lshr_b32 s51, s33, 1
    s_add_u32 s50, s50, s51
    s_lshl_b32 s50, s50, 2
    s_lshr_b32 s51, s35, 1
    s_add_u32 s50, s50, s51
    s_lshl_b32 s50, s50, 3
    s_lshl_b32 s51, s36, 2
    s_add_u32 s50, s50, s51
    s_and_b32 s51, s35, 1
    s_lshl_b32 s51, s51, 1
    s_add_u32 s50, s50, s51
    s_and_b32 s51, s33, 1
    s_add_u32 s50, s50, s51
    s_lshl_b32 s50, s50, 4
    s_add_u32 s50, s50, 147456
    s_waitcnt vmcnt(9)
    v_mov_b32 v62, 0
    v_mov_b32 v63, s32
    s_mov_b64 exec, 1
    buffer_store_dword v63, v62, s[16:19], s50 offen sc1
    s_mov_b64 exec, -1
    v_add_u32 v58, s62, v26
    v_mul_f32 v80, v64, v240
    v_mul_f32 v82, v66, v242
    v_mul_f32 v81, v64, v241
    v_mul_f32 v83, v66, v243
    v_fma_f32 v80, -v65, v241, v80
    v_fma_f32 v82, -v67, v243, v82
    v_fmac_f32 v81, v65, v240
    v_fmac_f32 v83, v67, v242
    v_cvt_pk_bf16_f32 v96, v80, v81
    v_cvt_pk_bf16_f32 v97, v82, v83
    v_mul_f32 v84, v68, v244
    v_mul_f32 v86, v70, v246
    v_mul_f32 v85, v68, v245
    v_mul_f32 v87, v70, v247
    v_fma_f32 v84, -v69, v245, v84
    v_fma_f32 v86, -v71, v247, v86
    v_fmac_f32 v85, v69, v244
    v_fmac_f32 v87, v71, v246
    v_cvt_pk_bf16_f32 v98, v84, v85
    v_cvt_pk_bf16_f32 v99, v86, v87
    v_mul_f32 v88, v72, v248
    v_mul_f32 v90, v74, v250
    v_mul_f32 v89, v72, v249
    v_mul_f32 v91, v74, v251
    v_fma_f32 v88, -v73, v249, v88
    v_fma_f32 v90, -v75, v251, v90
    v_fmac_f32 v89, v73, v248
    v_fmac_f32 v91, v75, v250
    v_cvt_pk_bf16_f32 v100, v88, v89
    v_cvt_pk_bf16_f32 v101, v90, v91
    ds_write_b128 v58, v[96:99] offset:40960
    v_mul_f32 v92, v76, v252
    v_mul_f32 v94, v78, v254
    v_mul_f32 v93, v76, v253
    v_mul_f32 v95, v78, v255
    v_fma_f32 v92, -v77, v253, v92
    v_fma_f32 v94, -v79, v255, v94
    v_fmac_f32 v93, v77, v252
    v_fmac_f32 v95, v79, v254
    v_cvt_pk_bf16_f32 v102, v92, v93
    v_cvt_pk_bf16_f32 v103, v94, v95
    ds_write_b128 v58, v[100:103] offset:41984
    s_waitcnt lgkmcnt(0)
    s_barrier
    ds_read_b128 a[192:195], v26 offset:40960
    ds_read_b128 a[196:199], v26 offset:41984
    ds_read_b128 a[200:203], v26 offset:43008
    ds_read_b128 a[204:207], v26 offset:44032
    ds_read_b128 a[208:211], v26 offset:45056
    ds_read_b128 a[212:215], v26 offset:46080
    ds_read_b128 a[216:219], v26 offset:47104
    ds_read_b128 a[220:223], v26 offset:48128
    s_lshl_b32 s50, s40, 2
    s_add_u32 s50, s50, s33
    s_lshl_b32 s50, s50, 7
    s_add_u32 s58, s50, 147456
    v_and_b32 v6, 7, v1
    v_lshlrev_b32 v6, 4, v6
    v_lshrrev_b32 v59, 4, v1
    s_waitcnt lgkmcnt(7)
    s_add_u32 m0, s56, 106496
    v_mfma_f32_32x32x16_bf16 v[64:79], a[160:163], a[192:195], 0
    s_lshl4_add_u32 s55, s68, s48
    buffer_load_dwordx4 v238, s[12:15], s55 offen lds
    v_bfe_u32 v60, v1, 3, 1
    v_lshlrev_b32 v60, 12, v60
    s_waitcnt lgkmcnt(6)
    v_mfma_f32_32x32x16_bf16 v[64:79], a[164:167], a[196:199], v[64:79]
    buffer_load_dwordx4 v239, s[12:15], s55 offen offset:1024 lds
    v_lshl_add_u32 v60, v59, 16, v60
    v_and_b32 v61, 15, v1
    s_waitcnt lgkmcnt(5)
    v_mfma_f32_32x32x16_bf16 v[64:79], a[168:171], a[200:203], v[64:79]
    v_lshlrev_b32 v61, 2, v61
    v_lshl_add_u32 v61, v59, 7, v61
    s_waitcnt lgkmcnt(4)
    v_mfma_f32_32x32x16_bf16 v[64:79], a[172:175], a[204:207], v[64:79]
    v_add_u32 v61, s62, v61
    v_and_b32 v59, 7, v1
    s_waitcnt lgkmcnt(3)
    v_mfma_f32_32x32x16_bf16 v[64:79], a[176:179], a[208:211], v[64:79]
    v_lshl_add_u32 v59, v59, 4, v60
    s_lshl_b32 s51, s33, 19
    s_waitcnt lgkmcnt(2)
    v_mfma_f32_32x32x16_bf16 v[64:79], a[180:183], a[212:215], v[64:79]
    s_lshl_b32 s52, s38, 7
    s_add_u32 s51, s51, s52
    s_waitcnt lgkmcnt(1)
    v_mfma_f32_32x32x16_bf16 v[64:79], a[184:187], a[216:219], v[64:79]
    s_lshl_b32 s52, s39, 13
    s_add_u32 s51, s51, s52
    s_waitcnt lgkmcnt(0)
    v_mfma_f32_32x32x16_bf16 v[64:79], a[188:191], a[220:223], v[64:79]
    s_add_u32 s51, s51, 3145728
    s_add_u32 s52, s51, 262144
    s_nop 9
    v_cvt_pk_bf16_f32 v96, v64, v65
    v_cvt_pk_bf16_f32 v97, v66, v67
    v_cvt_pk_bf16_f32 v98, v68, v69
    v_cvt_pk_bf16_f32 v99, v70, v71
    v_cvt_pk_bf16_f32 v100, v72, v73
    v_cvt_pk_bf16_f32 v101, v74, v75
    v_cvt_pk_bf16_f32 v102, v76, v77
    v_cvt_pk_bf16_f32 v103, v78, v79
    ds_write_b32 v61, v96 offset:32768
    ds_write_b32 v61, v97 offset:32832
    ds_write_b32 v61, v98 offset:33280
    ds_write_b32 v61, v99 offset:33344
    ds_write_b32 v61, v100 offset:33792
    ds_write_b32 v61, v101 offset:33856
    ds_write_b32 v61, v102 offset:34304
    ds_write_b32 v61, v103 offset:34368
    s_waitcnt lgkmcnt(0)
    ds_read_b128 v[64:67], v58 offset:32768
    ds_read_b128 v[68:71], v58 offset:33792
    s_waitcnt lgkmcnt(0)
    buffer_store_dwordx4 v[64:67], v59, s[16:19], s51 offen sc1
    buffer_store_dwordx4 v[68:71], v59, s[16:19], s52 offen sc1
    buffer_load_dword v7, v6, s[16:19], s58 offen sc1
    s_mul_i32 s50, s40, 229376
    s_add_u32 s50, s50, 5242880
    v_add_u32 v19, s50, v26
    v_add_u32 v20, 114688, v19
    ds_read_b64_tr_b16 a[56:57], v11 offset:0
    ds_read_b64_tr_b16 a[58:59], v11 offset:1024
    s_add_u32 m0, s56, 108544
    s_lshl4_add_u32 s55, s69, s48
    buffer_load_dwordx4 v238, s[12:15], s55 offen lds
    ds_read_b64_tr_b16 a[60:61], v12 offset:0
    ds_read_b64_tr_b16 a[62:63], v12 offset:1024
    buffer_load_dwordx4 v239, s[12:15], s55 offen offset:1024 lds
    ds_read_b64_tr_b16 a[64:65], v11 offset:8192
    s_add_u32 m0, s56, 110592
    s_lshl4_add_u32 s55, s70, s48
    buffer_load_dwordx4 v238, s[12:15], s55 offen lds
    ds_read_b64_tr_b16 a[66:67], v11 offset:9216
    ds_read_b64_tr_b16 a[68:69], v12 offset:8192
    ds_read_b64_tr_b16 a[70:71], v12 offset:9216
    buffer_load_dwordx4 v239, s[12:15], s55 offen offset:1024 lds
    s_add_u32 m0, s56, 112640
    s_lshl4_add_u32 s55, s71, s48
    buffer_load_dwordx4 v238, s[12:15], s55 offen lds
    ds_read_b64_tr_b16 a[72:73], v11 offset:16384
    ds_read_b64_tr_b16 a[74:75], v11 offset:17408
    ds_read_b64_tr_b16 a[76:77], v12 offset:16384
    buffer_load_dwordx4 v239, s[12:15], s55 offen offset:1024 lds
    ds_read_b64_tr_b16 a[78:79], v12 offset:17408
    s_waitcnt lgkmcnt(8)
    s_add_u32 m0, s47, 0
    s_lshl4_add_u32 s55, s72, s48
    buffer_load_dwordx4 v238, s[12:15], s55 offen lds
    ds_read_b64_tr_b16 a[0:1], v11 offset:24576
    ds_read_b64_tr_b16 a[2:3], v11 offset:25600
    buffer_load_dwordx4 v239, s[12:15], s55 offen offset:1024 lds
    ds_read_b64_tr_b16 a[4:5], v12 offset:24576
    ds_read_b64_tr_b16 a[6:7], v12 offset:25600
    s_waitcnt lgkmcnt(8)
    s_add_u32 m0, s47, 2048
    s_lshl4_add_u32 s55, s73, s48
    buffer_load_dwordx4 v238, s[12:15], s55 offen lds
    ds_read_b64_tr_b16 a[8:9], v11 offset:32768
    buffer_load_dwordx4 v239, s[12:15], s55 offen offset:1024 lds
    ds_read_b64_tr_b16 a[10:11], v11 offset:33792
    ds_read_b64_tr_b16 a[12:13], v12 offset:32768
    ds_read_b64_tr_b16 a[14:15], v12 offset:33792
    s_add_u32 m0, s47, 4096
    s_lshl4_add_u32 s55, s74, s48
    buffer_load_dwordx4 v238, s[12:15], s55 offen lds
    s_waitcnt lgkmcnt(8)
    s_waitcnt vmcnt(25)
    buffer_load_dwordx4 v239, s[12:15], s55 offen offset:1024 lds
    ds_read_b64_tr_b16 a[16:17], v11 offset:40960
    ds_read_b64_tr_b16 a[18:19], v11 offset:41984
    ds_read_b64_tr_b16 a[20:21], v12 offset:40960
    s_add_u32 m0, s47, 6144
    s_lshl4_add_u32 s55, s75, s48
    buffer_load_dwordx4 v238, s[12:15], s55 offen lds
    ds_read_b64_tr_b16 a[22:23], v12 offset:41984
    s_waitcnt lgkmcnt(8)
    buffer_load_dwordx4 v239, s[12:15], s55 offen offset:1024 lds
    v_mov_b32 v2, v238
    v_mov_b32 v3, v239
    s_waitcnt vmcnt(14)
    v_cmp_ne_u32 vcc, s32, v7
    s_nop 1
    s_cbranch_vccnz L_again_11
L_back_12:
    s_lshl_b32 s50, s33, 3
    s_add_u32 s50, s50, s39
    s_lshl_b32 s50, s50, 5
    s_add_u32 s50, s50, s38
    s_lshl_b32 s50, s50, 4
    s_add_u32 s50, s50, 163840
    s_branch L_join
L_typeB:
    s_add_u32 m0, s47, 4096
    s_add_u32 s50, s3, 0
    s_and_b32 s50, s50, 0x380
    buffer_load_dwordx4 v2, s[4:7], s50 offen offset:0  lds
    buffer_load_dwordx4 v3, s[4:7], s50 offen offset:1024  lds
    buffer_load_dwordx4 v4, s[4:7], s50 offen offset:2048  lds
    buffer_load_dwordx4 v5, s[4:7], s50 offen offset:3072  lds
    v_and_b32 v58, 31, v1
    v_lshrrev_b32 v59, 5, v1
    v_bfe_u32 v60, v1, 1, 3
    v_xor_b32 v60, v60, v59
    v_lshlrev_b32 v60, 4, v60
    v_lshl_add_u32 v60, v58, 7, v60
    v_add_u32 v9, s47, v60
    v_xor_b32 v10, 32, v9
    v_xor_b32 v11, 64, v9
    v_xor_b32 v12, 96, v9
    s_add_u32 s50, s56, 98304
    v_add_u32 v232, s50, v60
    v_xor_b32 v233, 32, v232
    v_xor_b32 v234, 64, v232
    v_xor_b32 v235, 96, v232
    v_bfe_u32 v58, v1, 2, 2
    v_lshl_add_u32 v60, v59, 3, v58
    v_and_b32 v61, 3, v1
    v_lshlrev_b32 v61, 3, v61
    v_and_b32 v62, 16, v1
    v_lshl_add_u32 v61, v62, 1, v61
    v_lshl_add_u32 v17, v60, 6, v61
    v_add_u32 v17, 98304, v17
    v_lshl_add_u32 v61, v60, 7, v61
    v_and_b32 v62, 8, v1
    v_lshl_add_u32 v61, v62, 3, v61
    v_add_u32 v13, 49152, v61
    v_xor_b32 v14, 64, v13
    v_add_u32 v15, 98304, v61
    v_xor_b32 v16, 64, v15
    s_lshl_b32 s50, s33, 11
    v_add_u32 v21, s50, v15
    v_add_u32 v22, s50, v16
    v_add_u32 v19, s50, v13
    v_add_u32 v20, s50, v14
    v_add_u32 v237, s61, v17
    v_add_u32 v18, 49152, v26
    v_mov_b32 v56, 0x3f803f80
    v_mov_b32 v57, 0x3f803f80
    v_and_b32 v204, 31, v1
    s_lshl_b32 s50, s35, 5
    v_add_u32 v204, s50, v204
    v_and_b32 v207, 1, v204
    v_lshlrev_b32 v207, 31, v207
    v_xor_b32 v25, 1.0, v207
    v_mov_b32 v207, 0x100
    v_cmp_eq_u32 vcc, 0, v204
    s_nop 1
    v_cndmask_b32 v204, v204, v207, vcc
    s_add_u32 s50, s37, s33
    s_lshl_b32 s50, s50, 6
    v_lshrrev_b32 v207, 5, v1
    v_lshlrev_b32 v207, 3, v207
    v_add_u32 v207, s50, v207
    v_mul_u32_u24 v207, v207, v204
    v_and_b32 v207, 511, v207
    v_cvt_f32_u32 v206, v207
    v_mul_f32 v206, 0x3b000000, v206
    v_cvt_f32_u32 v205, v204
    v_mul_f32 v205, 0x3b000000, v205
    s_lshl_b32 s50, s33, 13
    v_add_u32 v207, s50, v18
    v_mul_f32 v204, 0x41800000, v205
    v_cos_f32 v112, v204
    v_sin_f32 v114, v204
    v_cos_f32 v120, v206
    v_sin_f32 v96, v206
    v_add_f32 v206, v206, v205
    v_cos_f32 v121, v206
    v_sin_f32 v97, v206
    v_add_f32 v206, v206, v205
    v_cos_f32 v122, v206
    v_sin_f32 v98, v206
    v_add_f32 v206, v206, v205
    v_cos_f32 v123, v206
    v_sin_f32 v99, v206
    v_add_f32 v206, v206, v205
    v_cos_f32 v124, v206
    v_sin_f32 v100, v206
    v_add_f32 v206, v206, v205
    v_cos_f32 v125, v206
    v_sin_f32 v101, v206
    v_add_f32 v206, v206, v205
    v_cos_f32 v126, v206
    v_sin_f32 v102, v206
    v_add_f32 v206, v206, v205
    v_cos_f32 v127, v206
    v_sin_f32 v103, v206
    v_mov_b32 v113, v112
    v_mov_b32 v115, v114
    v_cvt_pk_bf16_f32 v216, v120, v121
    v_cvt_pk_bf16_f32 v217, v122, v123
    v_cvt_pk_bf16_f32 v218, v124, v125
    v_cvt_pk_bf16_f32 v219, v126, v127
    v_cvt_pk_bf16_f32 v224, -v96, -v97
    v_cvt_pk_bf16_f32 v225, -v98, -v99
    v_cvt_pk_bf16_f32 v226, -v100, -v101
    v_cvt_pk_bf16_f32 v227, -v102, -v103
    v_pk_mul_f32 v[104:105], v[96:97], v[114:115]
    v_pk_mul_f32 v[106:107], v[98:99], v[114:115]
    v_pk_mul_f32 v[108:109], v[100:101], v[114:115]
    v_pk_mul_f32 v[110:111], v[102:103], v[114:115]
    v_pk_mul_f32 v[96:97], v[96:97], v[112:113]
    v_pk_mul_f32 v[98:99], v[98:99], v[112:113]
    v_pk_mul_f32 v[100:101], v[100:101], v[112:113]
    v_pk_mul_f32 v[102:103], v[102:103], v[112:113]
    v_pk_fma_f32 v[96:97], v[120:121], v[114:115], v[96:97]
    v_pk_fma_f32 v[98:99], v[122:123], v[114:115], v[98:99]
    v_pk_fma_f32 v[100:101], v[124:125], v[114:115], v[100:101]
    v_pk_fma_f32 v[102:103], v[126:127], v[114:115], v[102:103]
    v_pk_fma_f32 v[120:121], v[120:121], v[112:113], v[104:105] neg_lo:[0,0,1] neg_hi:[0,0,1]
    v_pk_fma_f32 v[122:123], v[122:123], v[112:113], v[106:107] neg_lo:[0,0,1] neg_hi:[0,0,1]
    v_pk_fma_f32 v[124:125], v[124:125], v[112:113], v[108:109] neg_lo:[0,0,1] neg_hi:[0,0,1]
    v_pk_fma_f32 v[126:127], v[126:127], v[112:113], v[110:111] neg_lo:[0,0,1] neg_hi:[0,0,1]
    ds_write_b128 v207, v[216:219] offset:0
    ds_write_b128 v207, v[224:227] offset:1024
    v_cvt_pk_bf16_f32 v220, v120, v121
    v_cvt_pk_bf16_f32 v221, v122, v123
    v_cvt_pk_bf16_f32 v222, v124, v125
    v_cvt_pk_bf16_f32 v223, v126, v127
    v_cvt_pk_bf16_f32 v228, -v96, -v97
    v_cvt_pk_bf16_f32 v229, -v98, -v99
    v_cvt_pk_bf16_f32 v230, -v100, -v101
    v_cvt_pk_bf16_f32 v231, -v102, -v103
    v_pk_mul_f32 v[104:105], v[96:97], v[114:115]
    v_pk_mul_f32 v[106:107], v[98:99], v[114:115]
    v_pk_mul_f32 v[108:109], v[100:101], v[114:115]
    v_pk_mul_f32 v[110:111], v[102:103], v[114:115]
    v_pk_mul_f32 v[96:97], v[96:97], v[112:113]
    v_pk_mul_f32 v[98:99], v[98:99], v[112:113]
    v_pk_mul_f32 v[100:101], v[100:101], v[112:113]
    v_pk_mul_f32 v[102:103], v[102:103], v[112:113]
    v_pk_fma_f32 v[96:97], v[120:121], v[114:115], v[96:97]
    v_pk_fma_f32 v[98:99], v[122:123], v[114:115], v[98:99]
    v_pk_fma_f32 v[100:101], v[124:125], v[114:115], v[100:101]
    v_pk_fma_f32 v[102:103], v[126:127], v[114:115], v[102:103]
    v_pk_fma_f32 v[120:121], v[120:121], v[112:113], v[104:105] neg_lo:[0,0,1] neg_hi:[0,0,1]
    v_pk_fma_f32 v[122:123], v[122:123], v[112:113], v[106:107] neg_lo:[0,0,1] neg_hi:[0,0,1]
    v_pk_fma_f32 v[124:125], v[124:125], v[112:113], v[108:109] neg_lo:[0,0,1] neg_hi:[0,0,1]
    v_pk_fma_f32 v[126:127], v[126:127], v[112:113], v[110:111] neg_lo:[0,0,1] neg_hi:[0,0,1]
    ds_write_b128 v207, v[220:223] offset:2048
    ds_write_b128 v207, v[228:231] offset:3072
    s_waitcnt lgkmcnt(2)
    v_cvt_pk_bf16_f32 v216, v120, v121
    v_cvt_pk_bf16_f32 v217, v122, v123
    v_cvt_pk_bf16_f32 v218, v124, v125
    v_cvt_pk_bf16_f32 v219, v126, v127
    v_cvt_pk_bf16_f32 v224, -v96, -v97
    v_cvt_pk_bf16_f32 v225, -v98, -v99
    v_cvt_pk_bf16_f32 v226, -v100, -v101
    v_cvt_pk_bf16_f32 v227, -v102, -v103
    v_pk_mul_f32 v[104:105], v[96:97], v[114:115]
    v_pk_mul_f32 v[106:107], v[98:99], v[114:115]
    v_pk_mul_f32 v[108:109], v[100:101], v[114:115]
    v_pk_mul_f32 v[110:111], v[102:103], v[114:115]
    v_pk_mul_f32 v[96:97], v[96:97], v[112:113]
    v_pk_mul_f32 v[98:99], v[98:99], v[112:113]
    v_pk_mul_f32 v[100:101], v[100:101], v[112:113]
    v_pk_mul_f32 v[102:103], v[102:103], v[112:113]
    v_pk_fma_f32 v[96:97], v[120:121], v[114:115], v[96:97]
    v_pk_fma_f32 v[98:99], v[122:123], v[114:115], v[98:99]
    v_pk_fma_f32 v[100:101], v[124:125], v[114:115], v[100:101]
    v_pk_fma_f32 v[102:103], v[126:127], v[114:115], v[102:103]
    v_pk_fma_f32 v[120:121], v[120:121], v[112:113], v[104:105] neg_lo:[0,0,1] neg_hi:[0,0,1]
    v_pk_fma_f32 v[122:123], v[122:123], v[112:113], v[106:107] neg_lo:[0,0,1] neg_hi:[0,0,1]
    v_pk_fma_f32 v[124:125], v[124:125], v[112:113], v[108:109] neg_lo:[0,0,1] neg_hi:[0,0,1]
    v_pk_fma_f32 v[126:127], v[126:127], v[112:113], v[110:111] neg_lo:[0,0,1] neg_hi:[0,0,1]
    ds_write_b128 v207, v[216:219] offset:4096
    ds_write_b128 v207, v[224:227] offset:5120
    s_waitcnt lgkmcnt(2)
    v_cvt_pk_bf16_f32 v220, v120, v121
    v_cvt_pk_bf16_f32 v221, v122, v123
    v_cvt_pk_bf16_f32 v222, v124, v125
    v_cvt_pk_bf16_f32 v223, v126, v127
    v_cvt_pk_bf16_f32 v228, -v96, -v97
    v_cvt_pk_bf16_f32 v229, -v98, -v99
    v_cvt_pk_bf16_f32 v230, -v100, -v101
    v_cvt_pk_bf16_f32 v231, -v102, -v103
    ds_write_b128 v207, v[220:223] offset:6144
    ds_write_b128 v207, v[228:231] offset:7168
    s_waitcnt lgkmcnt(0)
    s_add_u32 m0, s56, 98304
    s_add_u32 s50, s3, 512
    s_and_b32 s50, s50, 0x380
    buffer_load_dwordx4 v2, s[4:7], s50 offen offset:0  lds
    buffer_load_dwordx4 v3, s[4:7], s50 offen offset:1024  lds
    buffer_load_dwordx4 v4, s[4:7], s50 offen offset:2048  lds
    buffer_load_dwordx4 v5, s[4:7], s50 offen offset:3072  lds
    s_waitcnt vmcnt(8)
    v_lshlrev_b32 v96, 16, v192
    v_and_b32 v97, 0xffff0000, v192
    v_lshlrev_b32 v98, 16, v193
    v_and_b32 v99, 0xffff0000, v193
    v_lshlrev_b32 v100, 16, v194
    v_and_b32 v101, 0xffff0000, v194
    v_lshlrev_b32 v102, 16, v195
    v_and_b32 v103, 0xffff0000, v195
    v_lshlrev_b32 v104, 16, v196
    v_and_b32 v105, 0xffff0000, v196
    v_lshlrev_b32 v106, 16, v197
    v_and_b32 v107, 0xffff0000, v197
    v_lshlrev_b32 v108, 16, v198
    v_and_b32 v109, 0xffff0000, v198
    v_lshlrev_b32 v110, 16, v199
    v_and_b32 v111, 0xffff0000, v199
    v_add_f32 v112, v96, v97
    v_add_f32 v113, v98, v99
    v_add_f32 v112, v112, v100
    v_add_f32 v113, v113, v101
    v_add_f32 v112, v112, v102
    v_add_f32 v113, v113, v103
    v_add_f32 v112, v112, v104
    v_add_f32 v113, v113, v105
    v_add_f32 v112, v112, v106
    v_add_f32 v113, v113, v107
    v_add_f32 v112, v112, v108
    v_add_f32 v113, v113, v109
    v_add_f32 v112, v112, v110
    v_add_f32 v113, v113, v111
    v_add_f32 v112, v112, v113
    s_nop 1
    v_add_f32_dpp v112, v112, v112 row_ror:8 row_mask:0xf bank_mask:0xf
    s_nop 1
    v_add_f32_dpp v112, v112, v112 row_ror:4 row_mask:0xf bank_mask:0xf
    s_nop 1
    v_add_f32_dpp v112, v112, v112 row_ror:2 row_mask:0xf bank_mask:0xf
    s_nop 1
    v_add_f32_dpp v112, v112, v112 row_ror:1 row_mask:0xf bank_mask:0xf
    v_mov_b32 v113, v112
    s_nop 1
    v_permlane16_swap_b32 v112, v113
    v_add_f32 v112, v112, v113
    v_mul_f32 v112, 0x3b000000, v112
    v_sub_f32 v96, v96, v112
    v_sub_f32 v97, v97, v112
    v_sub_f32 v98, v98, v112
    v_sub_f32 v99, v99, v112
    v_sub_f32 v100, v100, v112
    v_sub_f32 v101, v101, v112
    v_sub_f32 v102, v102, v112
    v_sub_f32 v103, v103, v112
    v_sub_f32 v104, v104, v112
    v_sub_f32 v105, v105, v112
    v_sub_f32 v106, v106, v112
    v_sub_f32 v107, v107, v112
    v_sub_f32 v108, v108, v112
    v_sub_f32 v109, v109, v112
    v_sub_f32 v110, v110, v112
    v_sub_f32 v111, v111, v112
    v_mul_f32 v96, v96, v96
    v_mul_f32 v97, v97, v97
    v_mul_f32 v98, v98, v98
    v_mul_f32 v99, v99, v99
    v_mul_f32 v100, v100, v100
    v_mul_f32 v101, v101, v101
    v_mul_f32 v102, v102, v102
    v_mul_f32 v103, v103, v103
    v_mul_f32 v104, v104, v104
    v_mul_f32 v105, v105, v105
    v_mul_f32 v106, v106, v106
    v_mul_f32 v107, v107, v107
    v_mul_f32 v108, v108, v108
    v_mul_f32 v109, v109, v109
    v_mul_f32 v110, v110, v110
    v_mul_f32 v111, v111, v111
    v_add_f32 v114, v96, v97
    v_add_f32 v115, v98, v99
    v_add_f32 v114, v114, v100
    v_add_f32 v115, v115, v101
    v_add_f32 v114, v114, v102
    v_add_f32 v115, v115, v103
    v_add_f32 v114, v114, v104
    v_add_f32 v115, v115, v105
    v_add_f32 v114, v114, v106
    v_add_f32 v115, v115, v107
    v_add_f32 v114, v114, v108
    v_add_f32 v115, v115, v109
    v_add_f32 v114, v114, v110
    v_add_f32 v115, v115, v111
    v_add_f32 v114, v114, v115
    s_nop 1
    v_add_f32_dpp v114, v114, v114 row_ror:8 row_mask:0xf bank_mask:0xf
    s_nop 1
    v_add_f32_dpp v114, v114, v114 row_ror:4 row_mask:0xf bank_mask:0xf
    s_nop 1
    v_add_f32_dpp v114, v114, v114 row_ror:2 row_mask:0xf bank_mask:0xf
    s_nop 1
    v_add_f32_dpp v114, v114, v114 row_ror:1 row_mask:0xf bank_mask:0xf
    v_mov_b32 v115, v114
    s_nop 1
    v_permlane16_swap_b32 v114, v115
    v_add_f32 v114, v114, v115
    v_mov_b32 v115, 0x3727c5ac
    v_fmac_f32 v115, 0x3b000000, v114
    v_rsq_f32 v114, v115
    v_readfirstlane_b32 s32, v240
    s_nop 1
    s_mul_i32 s32, s32, 0x9E3779B1
    s_add_u32 s32, s32, 0x7F4A7C15
    v_mov_b32 v113, s32
    v_mov_b32 v115, s32
    s_xor_b32 s54, s42, 4096
    s_lshr_b32 s54, s54, 1
    s_lshl_b32 s60, s49, 5
    s_add_u32 s54, s54, s60
    s_add_u32 s54, s54, 65536
    v_lshrrev_b32 v58, 5, v1
    v_lshlrev_b32 v58, 4, v58
    v_and_b32 v59, 31, v1
    v_cmp_eq_u32 vcc, 0, v59
    s_nop 1
    s_and_saveexec_b64 s[58:59], vcc
    buffer_store_dwordx4 v[112:115], v58, s[16:19], s54 offen sc1
    s_mov_b64 exec, s[58:59]
    v_and_b32 v204, 31, v1
    v_and_b32 v207, 1, v1
    s_mov_b32 s54, 0x80008000
    v_mul_lo_u32 v228, v207, s54
    v_cvt_f32_u32 v204, v204
    v_mul_f32 v205, 0x3d000000, v204
    s_lshr_b32 s54, s42, 10
    v_cvt_f32_u32 v206, s54
    v_mul_f32 v206, 0x3a000000, v206
    v_mul_f32 v206, v206, v204
    v_lshrrev_b32 v207, 5, v1
    v_lshlrev_b32 v207, 2, v207
    v_cvt_f32_u32 v207, v207
    v_fmac_f32 v206, v207, v205
    v_cos_f32 v208, v206
    v_sin_f32 v209, v206
    v_add_f32 v206, v206, v205
    v_cos_f32 v210, v206
    v_sin_f32 v211, v206
    v_add_f32 v206, v206, v205
    v_cos_f32 v212, v206
    v_sin_f32 v213, v206
    v_add_f32 v206, v206, v205
    v_cos_f32 v214, v206
    v_sin_f32 v215, v206
    v_fmac_f32 v206, 0x40a00000, v205
    v_cvt_pk_bf16_f32 v216, v208, v210
    v_cvt_pk_bf16_f32 v217, v209, v211
    v_cvt_pk_bf16_f32 v218, -v209, -v211
    v_xor_b32 v219, v216, v228
    v_xor_b32 v220, v217, v228
    v_xor_b32 v221, v218, v228
    v_accvgpr_write_b32 a192, v216
    v_accvgpr_write_b32 a196, v219
    v_accvgpr_write_b32 a200, v217
    v_accvgpr_write_b32 a204, v220
    v_accvgpr_write_b32 a208, v218
    v_accvgpr_write_b32 a212, v221
    v_cos_f32 v208, v206
    v_sin_f32 v209, v206
    v_add_f32 v206, v206, v205
    v_cos_f32 v210, v206
    v_sin_f32 v211, v206
    v_add_f32 v206, v206, v205
    v_cvt_pk_bf16_f32 v216, v212, v214
    v_cvt_pk_bf16_f32 v217, v213, v215
    v_cvt_pk_bf16_f32 v218, -v213, -v215
    v_xor_b32 v219, v216, v228
    v_xor_b32 v220, v217, v228
    v_xor_b32 v221, v218, v228
    v_accvgpr_write_b32 a193, v216
    v_accvgpr_write_b32 a197, v219
    v_accvgpr_write_b32 a201, v217
    v_accvgpr_write_b32 a205, v220
    v_accvgpr_write_b32 a209, v218
    v_accvgpr_write_b32 a213, v221
    v_cos_f32 v212, v206
    v_sin_f32 v213, v206
    v_add_f32 v206, v206, v205
    v_cos_f32 v214, v206
    v_sin_f32 v215, v206
    v_cvt_pk_bf16_f32 v216, v208, v210
    v_cvt_pk_bf16_f32 v217, v209, v211
    v_cvt_pk_bf16_f32 v218, -v209, -v211
    v_xor_b32 v219, v216, v228
    v_xor_b32 v220, v217, v228
    v_xor_b32 v221, v218, v228
    v_accvgpr_write_b32 a194, v216
    v_accvgpr_write_b32 a198, v219
    v_accvgpr_write_b32 a202, v217
    v_accvgpr_write_b32 a206, v220
    v_accvgpr_write_b32 a210, v218
    v_accvgpr_write_b32 a214, v221
    v_cvt_pk_bf16_f32 v216, v212, v214
    v_cvt_pk_bf16_f32 v217, v213, v215
    v_cvt_pk_bf16_f32 v218, -v213, -v215
    v_xor_b32 v219, v216, v228
    v_xor_b32 v220, v217, v228
    v_xor_b32 v221, v218, v228
    v_accvgpr_write_b32 a195, v216
    v_accvgpr_write_b32 a199, v219
    v_accvgpr_write_b32 a203, v217
    v_accvgpr_write_b32 a207, v220
    v_accvgpr_write_b32 a211, v218
    v_accvgpr_write_b32 a215, v221
    s_mov_b32 s50, 0xd5560004
    s_mov_b32 s51, 0xfffaaa
    v_lshlrev_b32 v204, 1, v1
    v_lshrrev_b64 v[208:209], v204, s[50:51]
    v_add_u32 v208, s40, v208
    v_and_b32 v208, 3, v208
    v_mul_u32_u24 v212, 7, v208
    v_and_b32 v204, 15, v1
    v_lshlrev_b32 v204, 2, v204
    s_mov_b32 s50, 0x65432100
    s_mov_b32 s51, 0x6543210
    v_lshrrev_b64 v[208:209], v204, s[50:51]
    s_mov_b32 s50, 0x21654321
    s_mov_b32 s51, 0x6543
    v_lshrrev_b64 v[210:211], v204, s[50:51]
    v_cmp_le_u32 vcc, 16, v1
    s_nop 1
    v_cndmask_b32 v208, v208, v210, vcc
    v_and_b32 v208, 7, v208
    s_and_b32 s50, s2, 7
    s_add_u32 s50, s50, s41
    v_add_u32 v204, s50, v208
    v_subrev_u32 v205, 14, v204
    v_min_u32 v204, v204, v205
    v_subrev_u32 v205, 7, v204
    v_min_u32 v204, v204, v205
    v_add_u32 v204, v204, v212
    s_mul_i32 s50, s33, 20
    s_lshl_b32 s51, s33, 3
    s_add_u32 s51, s51, 60
    v_mov_b32 v205, s50
    v_cmp_le_u32 vcc, 20, v204
    v_mov_b32 v206, s51
    s_nop 0
    v_cndmask_b32 v205, v205, v206, vcc
    v_add_lshl_u32 v204, v204, v205, 10
    s_nop 0
    v_readlane_b32 s64, v204, 0
    v_readlane_b32 s65, v204, 1
    v_readlane_b32 s66, v204, 2
    v_readlane_b32 s67, v204, 3
    v_readlane_b32 s68, v204, 4
    v_readlane_b32 s69, v204, 5
    v_readlane_b32 s70, v204, 6
    v_readlane_b32 s71, v204, 7
    v_readlane_b32 s72, v204, 8
    v_readlane_b32 s73, v204, 9
    v_readlane_b32 s74, v204, 10
    v_readlane_b32 s75, v204, 11
    v_readlane_b32 s76, v204, 12
    v_readlane_b32 s77, v204, 13
    v_readlane_b32 s78, v204, 14
    v_readlane_b32 s79, v204, 15
    v_readlane_b32 s80, v204, 16
    v_readlane_b32 s81, v204, 17
    v_readlane_b32 s82, v204, 18
    v_readlane_b32 s83, v204, 19
    v_readlane_b32 s84, v204, 20
    v_readlane_b32 s85, v204, 21
    v_readlane_b32 s86, v204, 22
    v_readlane_b32 s87, v204, 23
    v_readlane_b32 s88, v204, 24
    v_readlane_b32 s89, v204, 25
    v_readlane_b32 s90, v204, 26
    v_readlane_b32 s91, v204, 27
    v_lshrrev_b32 v228, 3, v1
    v_and_b32 v229, 7, v1
    v_lshlrev_b32 v229, 4, v229
    v_lshl_add_u32 v228, v228, 10, v229
    v_and_b32 v229, 16, v1
    v_lshlrev_b32 v229, 2, v229
    v_xor_b32 v238, v228, v229
    v_add_u32 v239, 7168, v238
    v_and_b32 v113, 15, v1
    v_lshlrev_b32 v113, 10, v113
    v_and_b32 v114, 16, v1
    v_lshlrev_b32 v114, 3, v114
    v_xor_b32 v114, s48, v114
    v_add_u32 v113, v113, v114
    s_waitcnt vmcnt(5)
    s_barrier
    ds_read_b128 a[0:3], v9 offset:4096
    ds_read_b128 a[216:219], v18 offset:0
    ds_read_b128 a[220:223], v18 offset:1024
    ds_read_b128 a[4:7], v10 offset:4096
    ds_read_b128 a[224:227], v18 offset:2048
    ds_read_b128 a[228:231], v18 offset:3072
    ds_read_b128 a[8:11], v11 offset:4096
    ds_read_b128 a[232:235], v18 offset:4096
    s_add_u32 m0, s47, 0
    s_add_u32 s50, s3, 128
    s_and_b32 s50, s50, 0x380
    buffer_load_dwordx4 v2, s[4:7], s50 offen offset:0  lds
    s_waitcnt lgkmcnt(6)
    v_mfma_f32_32x32x16_bf16 v[128:143], a[0:3], a[216:219], 0
    buffer_load_dwordx4 v3, s[4:7], s50 offen offset:1024  lds
    ds_read_b128 a[236:239], v18 offset:5120
    s_waitcnt lgkmcnt(6)
    v_mfma_f32_32x32x16_bf16 v[144:159], a[0:3], a[220:223], 0
    buffer_load_dwordx4 v4, s[4:7], s50 offen offset:2048  lds
    ds_read_b128 a[12:15], v12 offset:4096
    s_waitcnt lgkmcnt(5)
    v_mfma_f32_32x32x16_bf16 v[128:143], a[4:7], a[224:227], v[128:143]
    ds_read_b128 a[240:243], v18 offset:6144
    s_waitcnt lgkmcnt(5)
    v_mfma_f32_32x32x16_bf16 v[144:159], a[4:7], a[228:231], v[144:159]
    buffer_load_dwordx4 v5, s[4:7], s50 offen offset:3072  lds
    ds_read_b128 a[244:247], v18 offset:7168
    s_waitcnt lgkmcnt(4)
    v_mfma_f32_32x32x16_bf16 v[128:143], a[8:11], a[232:235], v[128:143]
    s_waitcnt vmcnt(5)
    s_barrier
    ds_read_b128 a[16:19], v232
    s_waitcnt lgkmcnt(4)
    s_add_u32 m0, s47, 4096
    v_mfma_f32_32x32x16_bf16 v[144:159], a[8:11], a[236:239], v[144:159]
    s_add_u32 s50, s3, 640
    s_and_b32 s50, s50, 0x380
    buffer_load_dwordx4 v2, s[4:7], s50 offen offset:0  lds
    ds_read_b128 a[20:23], v233
    s_waitcnt lgkmcnt(3)
    v_mfma_f32_32x32x16_bf16 v[128:143], a[12:15], a[240:243], v[128:143]
    ds_read_b128 a[24:27], v234
    s_waitcnt lgkmcnt(3)
    v_mfma_f32_32x32x16_bf16 v[144:159], a[12:15], a[244:247], v[144:159]
    buffer_load_dwordx4 v3, s[4:7], s50 offen offset:1024  lds
    s_waitcnt lgkmcnt(2)
    v_mfma_f32_32x32x16_bf16 v[160:175], a[16:19], a[216:219], 0
    ds_read_b128 a[28:31], v235
    v_mfma_f32_32x32x16_bf16 v[176:191], a[16:19], a[220:223], 0
    buffer_load_dwordx4 v4, s[4:7], s50 offen offset:2048  lds
    s_waitcnt lgkmcnt(2)
    v_mfma_f32_32x32x16_bf16 v[160:175], a[20:23], a[224:227], v[160:175]
    v_mfma_f32_32x32x16_bf16 v[176:191], a[20:23], a[228:231], v[176:191]
    buffer_load_dwordx4 v5, s[4:7], s50 offen offset:3072  lds
    s_waitcnt lgkmcnt(1)
    v_mfma_f32_32x32x16_bf16 v[160:175], a[24:27], a[232:235], v[160:175]
    s_waitcnt vmcnt(4)
    s_barrier
    ds_read_b128 a[32:35], v9 offset:0
    s_add_u32 m0, s56, 98304
    v_mfma_f32_32x32x16_bf16 v[176:191], a[24:27], a[236:239], v[176:191]
    s_add_u32 s50, s3, 256
    s_and_b32 s50, s50, 0x380
    buffer_load_dwordx4 v2, s[4:7], s50 offen offset:0  lds
    ds_read_b128 a[216:219], v18 offset:8192
    s_waitcnt lgkmcnt(2)
    v_mfma_f32_32x32x16_bf16 v[160:175], a[28:31], a[240:243], v[160:175]
    ds_read_b128 a[220:223], v18 offset:9216
    v_mfma_f32_32x32x16_bf16 v[176:191], a[28:31], a[244:247], v[176:191]
    buffer_load_dwordx4 v3, s[4:7], s50 offen offset:1024  lds
    ds_read_b128 a[36:39], v10 offset:0
    ds_read_b128 a[224:227], v18 offset:10240
    s_waitcnt lgkmcnt(3)
    v_mfma_f32_32x32x16_bf16 v[128:143], a[32:35], a[216:219], v[128:143]
    ds_read_b128 a[228:231], v18 offset:11264
    s_waitcnt lgkmcnt(3)
    v_mfma_f32_32x32x16_bf16 v[144:159], a[32:35], a[220:223], v[144:159]
    buffer_load_dwordx4 v4, s[4:7], s50 offen offset:2048  lds
    ds_read_b128 a[40:43], v11 offset:0
    ds_read_b128 a[232:235], v18 offset:12288
    s_waitcnt lgkmcnt(3)
    v_mfma_f32_32x32x16_bf16 v[128:143], a[36:39], a[224:227], v[128:143]
    ds_read_b128 a[236:239], v18 offset:13312
    s_waitcnt lgkmcnt(3)
    v_mfma_f32_32x32x16_bf16 v[144:159], a[36:39], a[228:231], v[144:159]
    buffer_load_dwordx4 v5, s[4:7], s50 offen offset:3072  lds
    ds_read_b128 a[44:47], v12 offset:0
    ds_read_b128 a[240:243], v18 offset:14336
    s_waitcnt lgkmcnt(3)
    v_mfma_f32_32x32x16_bf16 v[128:143], a[40:43], a[232:235], v[128:143]
    s_waitcnt vmcnt(4)
    s_barrier
    ds_read_b128 a[244:247], v18 offset:15360
    s_waitcnt lgkmcnt(3)
    s_add_u32 m0, s47, 0
    v_mfma_f32_32x32x16_bf16 v[144:159], a[40:43], a[236:239], v[144:159]
    s_add_u32 s50, s3, 768
    s_and_b32 s50, s50, 0x380
    buffer_load_dwordx4 v2, s[4:7], s50 offen offset:0  lds
    ds_read_b128 a[48:51], v9 offset:4096
    s_waitcnt lgkmcnt(2)
    v_mfma_f32_32x32x16_bf16 v[128:143], a[44:47], a[240:243], v[128:143]
    ds_read_b128 a[52:55], v10 offset:4096
    s_waitcnt lgkmcnt(2)
    v_mfma_f32_32x32x16_bf16 v[144:159], a[44:47], a[244:247], v[144:159]
    buffer_load_dwordx4 v3, s[4:7], s50 offen offset:1024  lds
    ds_read_b128 a[56:59], v11 offset:4096
    s_waitcnt lgkmcnt(2)
    v_mfma_f32_32x32x16_bf16 v[160:175], a[48:51], a[216:219], v[160:175]
    ds_read_b128 a[60:63], v12 offset:4096
    v_mfma_f32_32x32x16_bf16 v[176:191], a[48:51], a[220:223], v[176:191]
    buffer_load_dwordx4 v4, s[4:7], s50 offen offset:2048  lds
    s_waitcnt lgkmcnt(2)
    v_mfma_f32_32x32x16_bf16 v[160:175], a[52:55], a[224:227], v[160:175]
    v_mfma_f32_32x32x16_bf16 v[176:191], a[52:55], a[228:231], v[176:191]
    buffer_load_dwordx4 v5, s[4:7], s50 offen offset:3072  lds
    s_waitcnt lgkmcnt(1)
    v_mfma_f32_32x32x16_bf16 v[160:175], a[56:59], a[232:235], v[160:175]
    s_waitcnt vmcnt(4)
    s_barrier
    ds_read_b128 a[64:67], v232
    s_add_u32 m0, s47, 4096
    v_mfma_f32_32x32x16_bf16 v[176:191], a[56:59], a[236:239], v[176:191]
    s_add_u32 s50, s3, 384
    s_and_b32 s50, s50, 0x380
    buffer_load_dwordx4 v2, s[4:7], s50 offen offset:0  lds
    ds_read_b128 a[216:219], v18 offset:16384
    s_waitcnt lgkmcnt(2)
    v_mfma_f32_32x32x16_bf16 v[160:175], a[60:63], a[240:243], v[160:175]
    ds_read_b128 a[220:223], v18 offset:17408
    v_mfma_f32_32x32x16_bf16 v[176:191], a[60:63], a[244:247], v[176:191]
    buffer_load_dwordx4 v3, s[4:7], s50 offen offset:1024  lds
    ds_read_b128 a[68:71], v233
    ds_read_b128 a[224:227], v18 offset:18432
    s_waitcnt lgkmcnt(3)
    v_mfma_f32_32x32x16_bf16 v[128:143], a[64:67], a[216:219], v[128:143]
    ds_read_b128 a[228:231], v18 offset:19456
    s_waitcnt lgkmcnt(3)
    v_mfma_f32_32x32x16_bf16 v[144:159], a[64:67], a[220:223], v[144:159]
    buffer_load_dwordx4 v4, s[4:7], s50 offen offset:2048  lds
    ds_read_b128 a[72:75], v234
    ds_read_b128 a[232:235], v18 offset:20480
    s_waitcnt lgkmcnt(3)
    v_mfma_f32_32x32x16_bf16 v[128:143], a[68:71], a[224:227], v[128:143]
    ds_read_b128 a[236:239], v18 offset:21504
    s_waitcnt lgkmcnt(3)
    v_mfma_f32_32x32x16_bf16 v[144:159], a[68:71], a[228:231], v[144:159]
    buffer_load_dwordx4 v5, s[4:7], s50 offen offset:3072  lds
    ds_read_b128 a[76:79], v235
    ds_read_b128 a[240:243], v18 offset:22528
    s_waitcnt lgkmcnt(3)
    v_mfma_f32_32x32x16_bf16 v[128:143], a[72:75], a[232:235], v[128:143]
    s_waitcnt vmcnt(4)
    s_barrier
    ds_read_b128 a[244:247], v18 offset:23552
    s_lshr_b32 s63, s42, 1
    s_add_u32 s63, s63, 65536
    v_and_b32 v62, 31, v1
    v_lshlrev_b32 v62, 4, v62
    buffer_load_dwordx4 v[192:195], v62, s[16:19], s63 offen sc1
    s_waitcnt lgkmcnt(3)
    s_add_u32 m0, s56, 98304
    v_mfma_f32_32x32x16_bf16 v[144:159], a[72:75], a[236:239], v[144:159]
    s_add_u32 s50, s3, 896
    s_and_b32 s50, s50, 0x380
    buffer_load_dwordx4 v2, s[4:7], s50 offen offset:0  lds
    ds_read_b128 a[80:83], v9 offset:0
    s_waitcnt lgkmcnt(2)
    v_mfma_f32_32x32x16_bf16 v[128:143], a[76:79], a[240:243], v[128:143]
    ds_read_b128 a[84:87], v10 offset:0
    s_waitcnt lgkmcnt(2)
    v_mfma_f32_32x32x16_bf16 v[144:159], a[76:79], a[244:247], v[144:159]
    buffer_load_dwordx4 v3, s[4:7], s50 offen offset:1024  lds
    ds_read_b128 a[88:91], v11 offset:0
    s_waitcnt lgkmcnt(2)
    v_mfma_f32_32x32x16_bf16 v[160:175], a[80:83], a[216:219], v[160:175]
    ds_read_b128 a[92:95], v12 offset:0
    v_mfma_f32_32x32x16_bf16 v[176:191], a[80:83], a[220:223], v[176:191]
    buffer_load_dwordx4 v4, s[4:7], s50 offen offset:2048  lds
    s_waitcnt lgkmcnt(2)
    v_mfma_f32_32x32x16_bf16 v[160:175], a[84:87], a[224:227], v[160:175]
    v_mfma_f32_32x32x16_bf16 v[176:191], a[84:87], a[228:231], v[176:191]
    buffer_load_dwordx4 v5, s[4:7], s50 offen offset:3072  lds
    s_waitcnt lgkmcnt(1)
    v_mfma_f32_32x32x16_bf16 v[160:175], a[88:91], a[232:235], v[160:175]
    s_waitcnt vmcnt(5)
    s_barrier
    ds_read_b128 a[96:99], v9 offset:4096
    v_mfma_f32_32x32x16_bf16 v[176:191], a[88:91], a[236:239], v[176:191]
    s_add_u32 m0, s62, 102400
    s_add_u32 s51, s3, 0
    s_and_b32 s51, s51, 0x380
    s_mul_i32 s51, s51, 1792
    buffer_load_dwordx4 v6, s[8:11], s51 offen offset:0  lds
    ds_read_b128 a[216:219], v18 offset:24576
    s_waitcnt lgkmcnt(2)
    v_mfma_f32_32x32x16_bf16 v[160:175], a[92:95], a[240:243], v[160:175]
    buffer_load_dwordx4 v7, s[8:11], s51 offen offset:1024  lds
    ds_read_b128 a[220:223], v18 offset:25600
    v_mfma_f32_32x32x16_bf16 v[176:191], a[92:95], a[244:247], v[176:191]
    s_add_u32 m0, s62, 118784
    s_add_u32 s51, s3, 512
    s_and_b32 s51, s51, 0x380
    s_mul_i32 s51, s51, 1792
    buffer_load_dwordx4 v6, s[8:11], s51 offen offset:0  lds
    ds_read_b128 a[100:103], v10 offset:4096
    ds_read_b128 a[224:227], v18 offset:26624
    s_waitcnt lgkmcnt(3)
    v_mfma_f32_32x32x16_bf16 v[128:143], a[96:99], a[216:219], v[128:143]
    buffer_load_dwordx4 v7, s[8:11], s51 offen offset:1024  lds
    ds_read_b128 a[228:231], v18 offset:27648
    s_waitcnt lgkmcnt(3)
    v_mfma_f32_32x32x16_bf16 v[144:159], a[96:99], a[220:223], v[144:159]
    v_and_b32 v230, 7, v1
    v_cmp_gt_u32 vcc, 5, v230
    v_lshlrev_b32 v231, 4, v230
    s_nop 0
    v_cndmask_b32 v231, 0, v231, vcc
    s_lshl_b32 s59, s39, 6
    v_add_u32 v231, s59, v231
    s_cmp_eq_u32 s39, 0
    s_cselect_b32 s59, 5, 8
    v_mov_b32 v227, 0x200
    v_cmp_eq_u32 vcc, s59, v230
    s_nop 1
    v_cndmask_b32 v231, v231, v227, vcc
    v_subrev_u32 v227, 64, v231
    v_cmp_eq_u32 vcc, 6, v230
    s_nop 1
    v_cndmask_b32 v231, v231, v227, vcc
    v_lshrrev_b32 v230, 3, v1
    v_mul_u32_u24 v230, 16448, v230
    v_add_u32 v236, v230, v231
    s_lshl_b32 s58, s33, 9
    s_add_u32 s58, s58, s38
    s_mul_i32 s58, s58, 514
    s_and_b32 s58, s58, -16
    s_add_u32 s59, s56, 110592
    ds_read_b128 a[104:107], v11 offset:4096
    ds_read_b128 a[232:235], v18 offset:28672
    s_waitcnt lgkmcnt(3)
    v_mfma_f32_32x32x16_bf16 v[128:143], a[100:103], a[224:227], v[128:143]
    s_mov_b32 m0, s59
    s_nop 0
    buffer_load_dwordx4 v236, s[20:23], s58 offen lds
    ds_read_b128 a[236:239], v18 offset:29696
    s_waitcnt lgkmcnt(3)
    s_add_u32 m0, s59, 2048
    v_mfma_f32_32x32x16_bf16 v[144:159], a[100:103], a[228:231], v[144:159]
    s_nop 0
    buffer_load_dwordx4 v236, s[24:27], s58 offen lds
    ds_read_b128 a[108:111], v12 offset:4096
    ds_read_b128 a[240:243], v18 offset:30720
    s_waitcnt lgkmcnt(3)
    v_mfma_f32_32x32x16_bf16 v[128:143], a[104:107], a[232:235], v[128:143]
    s_waitcnt vmcnt(6)
    s_barrier
    s_add_u32 m0, s59, 1024
    s_add_u32 s58, s58, 131584
    buffer_load_dwordx4 v236, s[20:23], s58 offen lds
    ds_read_b128 a[244:247], v18 offset:31744
    s_waitcnt lgkmcnt(3)
    s_add_u32 m0, s59, 3072
    v_mfma_f32_32x32x16_bf16 v[144:159], a[104:107], a[236:239], v[144:159]
    s_nop 0
    buffer_load_dwordx4 v236, s[24:27], s58 offen lds
    ds_read_b128 a[112:115], v232
    s_waitcnt lgkmcnt(2)
    v_mfma_f32_32x32x16_bf16 v[128:143], a[108:111], a[240:243], v[128:143]
    ds_read_b128 a[116:119], v233
    v_cmp_ne_u32 vcc, s32, v193
    v_cmp_ne_u32 s[54:55], s32, v195
    s_nop 1
    s_or_b64 vcc, vcc, s[54:55]
    s_cbranch_vccnz L_again_14
L_back_15:
    v_mul_f32 v23, 0xbfb8aa3b, v194
    v_rcp_f32 v24, v194
    v_cvt_pk_bf16_f32 v28, -v192, -v192
    v_mov_b32 v30, 0
    v_and_b32 v193, 0xffff0000, v28
    v_mov_b32 v31, 0
    v_sub_f32 v193, -v192, v193
    v_cvt_pk_bf16_f32 v29, v193, v30
    s_lshl_b32 s60, s33, 7
    v_lshrrev_b32 v62, 2, v62
    v_add_u32 v62, s60, v62
    ds_write_b32 v62, v194 offset:46080
    s_waitcnt lgkmcnt(3)
    v_mfma_f32_32x32x16_bf16 v[144:159], a[108:111], a[244:247], v[144:159]
    s_add_u32 m0, s62, 135168
    s_add_u32 s51, s3, 128
    s_and_b32 s51, s51, 0x380
    s_mul_i32 s51, s51, 1792
    buffer_load_dwordx4 v6, s[8:11], s51 offen offset:0  lds
    ds_read_b128 a[120:123], v234
    s_waitcnt lgkmcnt(1)
    v_mfma_f32_32x32x16_bf16 v[160:175], a[112:115], a[216:219], v[160:175]
    ds_read_b128 a[124:127], v235
    s_lshl_b32 s60, s33, 7
    v_lshrrev_b32 v224, 5, v1
    v_lshlrev_b32 v224, 4, v224
    v_add_u32 v224, s60, v224
    ds_read_b128 v[208:211], v224 offset:46080
    ds_read_b128 v[212:215], v224 offset:46112
    v_mfma_f32_32x32x16_bf16 v[176:191], a[112:115], a[220:223], v[176:191]
    buffer_load_dwordx4 v7, s[8:11], s51 offen offset:1024  lds
    ds_read_b128 v[216:219], v224 offset:46144
    ds_read_b128 v[220:223], v224 offset:46176
    v_mfma_f32_32x32x16_bf16 v[160:175], a[116:119], a[224:227], v[160:175]
    v_and_b32 v225, 31, v1
    v_or_b32 v225, s35, v225
    v_mov_b32 v226, 0x36000000
    v_mov_b32 v227, 0x35800000
    v_cmp_eq_u32 vcc, 0, v225
    s_nop 1
    v_cndmask_b32 v226, v226, v227, vcc
    v_mov_b32 v58, v25
    v_mfma_f32_32x32x16_bf16 v[176:191], a[116:119], a[228:231], v[176:191]
    s_add_u32 m0, s62, 151552
    s_add_u32 s51, s3, 640
    s_and_b32 s51, s51, 0x380
    s_mul_i32 s51, s51, 1792
    buffer_load_dwordx4 v6, s[8:11], s51 offen offset:0  lds
    v_mov_b32 v59, v25
    s_waitcnt lgkmcnt(0)
    v_mfma_f32_32x32x16_bf16 v[160:175], a[120:123], a[232:235], v[160:175]
    v_mul_f32 v208, v208, v226
    v_mul_f32 v209, v209, v226
    v_mul_f32 v210, v210, v226
    v_mul_f32 v211, v211, v226
    v_mul_f32 v212, v212, v226
    v_mul_f32 v213, v213, v226
    v_mul_f32 v214, v214, v226
    v_mfma_f32_32x32x16_bf16 v[176:191], a[120:123], a[236:239], v[176:191]
    buffer_load_dwordx4 v7, s[8:11], s51 offen offset:1024  lds
    v_mul_f32 v215, v215, v226
    v_mul_f32 v216, v216, v226
    v_mfma_f32_32x32x16_bf16 v[160:175], a[124:127], a[240:243], v[160:175]
    v_mul_f32 v217, v217, v226
    v_mul_f32 v218, v218, v226
    v_mul_f32 v219, v219, v226
    v_mul_f32 v220, v220, v226
    v_mul_f32 v221, v221, v226
    v_mul_f32 v222, v222, v226
    v_mul_f32 v223, v223, v226
    v_mfma_f32_32x32x16_bf16 v[176:191], a[124:127], a[244:247], v[176:191]
    v_min_u32 v228, 27, v1
    v_lshlrev_b32 v228, 7, v228
    s_lshr_b32 s54, s2, 4
    s_lshl_b32 s54, s54, 3
    s_and_b32 s60, s2, 7
    s_add_u32 s54, s54, s60
    s_lshl_b32 s54, s54, 2
    s_add_u32 s54, s54, s33
    s_mul_i32 s54, s54, 3584
    buffer_load_dword v229, v228, s[12:15], s54 offen
    v_pk_fma_f32 v[128:129], v[160:161], v[58:59], v[128:129]
    v_pk_fma_f32 v[130:131], v[162:163], v[58:59], v[130:131]
    v_pk_fma_f32 v[132:133], v[164:165], v[58:59], v[132:133]
    v_pk_fma_f32 v[134:135], v[166:167], v[58:59], v[134:135]
    v_pk_fma_f32 v[136:137], v[168:169], v[58:59], v[136:137]
    v_pk_fma_f32 v[138:139], v[170:171], v[58:59], v[138:139]
    v_pk_fma_f32 v[140:141], v[172:173], v[58:59], v[140:141]
    v_pk_fma_f32 v[142:143], v[174:175], v[58:59], v[142:143]
    v_pk_mul_f32 v[128:129], v[128:129], v[208:209]
    v_pk_mul_f32 v[130:131], v[130:131], v[210:211]
    v_pk_mul_f32 v[132:133], v[132:133], v[212:213]
    v_pk_mul_f32 v[134:135], v[134:135], v[214:215]
    v_pk_mul_f32 v[136:137], v[136:137], v[216:217]
    v_pk_mul_f32 v[138:139], v[138:139], v[218:219]
    v_pk_mul_f32 v[140:141], v[140:141], v[220:221]
    v_pk_mul_f32 v[142:143], v[142:143], v[222:223]
    v_pk_fma_f32 v[144:145], v[176:177], v[58:59], v[144:145]
    v_pk_fma_f32 v[146:147], v[178:179], v[58:59], v[146:147]
    v_pk_fma_f32 v[148:149], v[180:181], v[58:59], v[148:149]
    v_pk_fma_f32 v[150:151], v[182:183], v[58:59], v[150:151]
    v_pk_fma_f32 v[152:153], v[184:185], v[58:59], v[152:153]
    v_pk_fma_f32 v[154:155], v[186:187], v[58:59], v[154:155]
    v_pk_fma_f32 v[156:157], v[188:189], v[58:59], v[156:157]
    v_pk_fma_f32 v[158:159], v[190:191], v[58:59], v[158:159]
    v_pk_mul_f32 v[144:145], v[144:145], v[208:209]
    v_pk_mul_f32 v[146:147], v[146:147], v[210:211]
    v_pk_mul_f32 v[148:149], v[148:149], v[212:213]
    v_pk_mul_f32 v[150:151], v[150:151], v[214:215]
    v_pk_mul_f32 v[152:153], v[152:153], v[216:217]
    v_pk_mul_f32 v[154:155], v[154:155], v[218:219]
    v_pk_mul_f32 v[156:157], v[156:157], v[220:221]
    v_pk_mul_f32 v[158:159], v[158:159], v[222:223]
    v_cvt_pk_bf16_f32 v160, v128, v129
    v_cvt_pk_bf16_f32 v161, v130, v131
    v_cvt_pk_bf16_f32 v162, v132, v133
    v_cvt_pk_bf16_f32 v163, v134, v135
    v_cvt_pk_bf16_f32 v164, v136, v137
    v_cvt_pk_bf16_f32 v165, v138, v139
    v_cvt_pk_bf16_f32 v166, v140, v141
    v_cvt_pk_bf16_f32 v167, v142, v143
    v_cvt_pk_bf16_f32 v168, v144, v145
    v_cvt_pk_bf16_f32 v169, v146, v147
    v_cvt_pk_bf16_f32 v170, v148, v149
    v_cvt_pk_bf16_f32 v171, v150, v151
    v_cvt_pk_bf16_f32 v172, v152, v153
    v_cvt_pk_bf16_f32 v173, v154, v155
    v_cvt_pk_bf16_f32 v174, v156, v157
    v_cvt_pk_bf16_f32 v175, v158, v159
    v_mfma_f32_32x32x16_bf16 v[128:143], a[192:195], v[160:163], 0
    v_mfma_f32_32x32x16_bf16 v[144:159], a[208:211], v[160:163], 0
    v_mfma_f32_32x32x16_bf16 v[128:143], a[196:199], v[164:167], v[128:143]
    v_mfma_f32_32x32x16_bf16 v[144:159], a[212:215], v[164:167], v[144:159]
    s_waitcnt vmcnt(11)
    s_barrier
    ds_read_b64_tr_b16 a[224:225], v15 offset:4096
    ds_read_b64_tr_b16 a[226:227], v15 offset:4608
    ds_read_b64_tr_b16 a[228:229], v16 offset:4096
    ds_read_b64_tr_b16 a[230:231], v16 offset:4608
    ds_read_b64_tr_b16 a[232:233], v15 offset:6144
    ds_read_b64_tr_b16 a[234:235], v15 offset:6656
    ds_read_b64_tr_b16 a[236:237], v16 offset:6144
    ds_read_b64_tr_b16 a[238:239], v16 offset:6656
    ds_read_b64_tr_b16 a[240:241], v15 offset:8192
    ds_read_b64_tr_b16 a[242:243], v15 offset:8704
    ds_read_b64_tr_b16 a[244:245], v16 offset:8192
    ds_read_b64_tr_b16 a[246:247], v16 offset:8704
    v_mfma_f32_32x32x16_bf16 v[128:143], a[200:203], v[168:171], v[128:143]
    v_mfma_f32_32x32x16_bf16 v[144:159], a[192:195], v[168:171], v[144:159]
    v_mfma_f32_32x32x16_bf16 v[128:143], a[204:207], v[172:175], v[128:143]
    v_mfma_f32_32x32x16_bf16 v[144:159], a[196:199], v[172:175], v[144:159]
    s_waitcnt lgkmcnt(10)
    v_mfma_f32_32x32x16_bf16 v[64:79], a[224:227], a[0:3], 0
    s_add_u32 m0, s62, 81920
    s_add_u32 s51, s3, 256
    s_and_b32 s51, s51, 0x380
    s_mul_i32 s51, s51, 1792
    buffer_load_dwordx4 v6, s[8:11], s51 offen offset:0  lds
    ds_read_b64_tr_b16 a[216:217], v15 offset:10240
    ds_read_b64_tr_b16 a[218:219], v15 offset:10752
    v_lshrrev_b32 v224, 5, v1
    s_waitcnt lgkmcnt(10)
    v_mfma_f32_32x32x16_bf16 v[80:95], a[228:231], a[0:3], 0
    ds_read_b64_tr_b16 v[48:49], v21 offset:4096
    ds_read_b64_tr_b16 v[50:51], v21 offset:4608
    ds_read_b64_tr_b16 v[52:53], v22 offset:4096
    ds_read_b64_tr_b16 v[54:55], v22 offset:4608
    v_and_b32 v225, 31, v1
    v_lshlrev_b32 v225, 4, v225
    s_waitcnt lgkmcnt(12)
    v_mfma_f32_32x32x16_bf16 v[64:79], a[232:235], a[4:7], v[64:79]
    buffer_load_dwordx4 v7, s[8:11], s51 offen offset:1024  lds
    ds_read_b64_tr_b16 a[220:221], v16 offset:10240
    ds_read_b64_tr_b16 a[222:223], v16 offset:10752
    v_lshl_add_u32 v224, v224, 11, v225
    s_waitcnt lgkmcnt(12)
    v_mfma_f32_32x32x16_bf16 v[80:95], a[236:239], a[4:7], v[80:95]
    s_lshl_b32 s60, s33, 2
    s_add_u32 s60, s60, 49152
    v_add_u32 v224, s60, v224
    v_cvt_pk_bf16_f32 v160, v128, v144
    v_cvt_pk_bf16_f32 v161, v129, v145
    v_cvt_pk_bf16_f32 v162, v130, v146
    v_cvt_pk_bf16_f32 v163, v131, v147
    s_waitcnt lgkmcnt(2)
    v_mfma_f32_4x4x4_16b_bf16 v[40:43], v[56:57], v[48:49], 0
    v_mfma_f32_4x4x4_16b_bf16 v[44:47], v[56:57], v[52:53], 0
    s_nop 0
    v_mfma_f32_4x4x4_16b_bf16 v[40:43], v[56:57], v[50:51], v[40:43]
    v_mfma_f32_4x4x4_16b_bf16 v[44:47], v[56:57], v[54:55], v[44:47]
    v_mfma_f32_32x32x16_bf16 v[64:79], a[240:243], a[8:11], v[64:79]
    s_waitcnt vmcnt(11)
    s_barrier
    s_add_u32 m0, s62, 90112
    s_add_u32 s51, s3, 768
    s_and_b32 s51, s51, 0x380
    s_mul_i32 s51, s51, 1792
    buffer_load_dwordx4 v6, s[8:11], s51 offen offset:0  lds
    ds_read_b64_tr_b16 a[224:225], v15 offset:20480
    ds_read_b64_tr_b16 a[226:227], v15 offset:20992
    v_cvt_pk_bf16_f32 v164, v132, v148
    v_mfma_f32_32x32x16_bf16 v[80:95], a[244:247], a[8:11], v[80:95]
    ds_read_b64_tr_b16 a[228:229], v16 offset:20480
    ds_read_b64_tr_b16 a[230:231], v16 offset:20992
    ds_read_b64_tr_b16 a[232:233], v15 offset:22528
    ds_write_b32 v224, v160 offset:0
    v_cvt_pk_bf16_f32 v165, v133, v149
    ds_write_b32 v224, v161 offset:512
    v_mfma_f32_32x32x16_bf16 v[64:79], a[216:219], a[12:15], v[64:79]
    buffer_load_dwordx4 v7, s[8:11], s51 offen offset:1024  lds
    ds_read_b64_tr_b16 v[48:49], v21 offset:20480
    ds_read_b64_tr_b16 v[50:51], v21 offset:20992
    ds_read_b64_tr_b16 v[52:53], v22 offset:20480
    ds_read_b64_tr_b16 v[54:55], v22 offset:20992
    v_cvt_pk_bf16_f32 v166, v134, v150
    s_waitcnt lgkmcnt(11)
    v_mfma_f32_32x32x16_bf16 v[80:95], a[220:223], a[12:15], v[80:95]
    ds_read_b64_tr_b16 a[234:235], v15 offset:23040
    ds_read_b64_tr_b16 a[236:237], v16 offset:22528
    ds_read_b64_tr_b16 a[238:239], v16 offset:23040
    ds_write_b32 v224, v162 offset:1024
    v_cvt_pk_bf16_f32 v167, v135, v151
    ds_write_b32 v224, v163 offset:1536
    v_cvt_pk_bf16_f32 v168, v136, v152
    s_waitcnt lgkmcnt(14)
    v_mfma_f32_32x32x16_bf16 v[64:79], a[224:227], a[16:19], v[64:79]
    ds_read_b64_tr_b16 a[240:241], v15 offset:24576
    ds_read_b64_tr_b16 a[242:243], v15 offset:25088
    ds_read_b64_tr_b16 a[244:245], v16 offset:24576
    ds_write_b32 v224, v164 offset:4096
    v_cvt_pk_bf16_f32 v169, v137, v153
    ds_write_b32 v224, v165 offset:4608
    s_waitcnt lgkmcnt(15)
    v_mfma_f32_32x32x16_bf16 v[80:95], a[228:231], a[16:19], v[80:95]
    ds_read_b64_tr_b16 a[246:247], v16 offset:25088
    ds_read_b64_tr_b16 a[216:217], v15 offset:26624
    ds_read_b64_tr_b16 a[218:219], v15 offset:27136
    v_cvt_pk_bf16_f32 v170, v138, v154
    ds_write_b32 v224, v166 offset:5120
    v_cvt_pk_bf16_f32 v171, v139, v155
    ds_write_b32 v224, v167 offset:5632
    s_waitcnt lgkmcnt(15)
    v_mfma_f32_4x4x4_16b_bf16 v[40:43], v[56:57], v[48:49], v[40:43]
    v_mfma_f32_4x4x4_16b_bf16 v[44:47], v[56:57], v[52:53], v[44:47]
    s_nop 0
    v_mfma_f32_4x4x4_16b_bf16 v[40:43], v[56:57], v[50:51], v[40:43]
    v_mfma_f32_4x4x4_16b_bf16 v[44:47], v[56:57], v[54:55], v[44:47]
    s_waitcnt lgkmcnt(14)
    v_mfma_f32_32x32x16_bf16 v[64:79], a[232:235], a[20:23], v[64:79]
    ds_read_b64_tr_b16 a[220:221], v16 offset:26624
    ds_read_b64_tr_b16 a[222:223], v16 offset:27136
    v_cvt_pk_bf16_f32 v172, v140, v156
    ds_write_b32 v224, v168 offset:8192
    v_cvt_pk_bf16_f32 v173, v141, v157
    ds_write_b32 v224, v169 offset:8704
    v_cvt_pk_bf16_f32 v174, v142, v158
    s_waitcnt lgkmcnt(15)
    v_mfma_f32_32x32x16_bf16 v[80:95], a[236:239], a[20:23], v[80:95]
    ds_write_b32 v224, v170 offset:9216
    v_cvt_pk_bf16_f32 v175, v143, v159
    ds_write_b32 v224, v171 offset:9728
    ds_write_b32 v224, v172 offset:12288
    ds_write_b32 v224, v173 offset:12800
    ds_write_b32 v224, v174 offset:13312
    ds_write_b32 v224, v175 offset:13824
    s_waitcnt lgkmcnt(15)
    v_mfma_f32_32x32x16_bf16 v[64:79], a[240:243], a[24:27], v[64:79]
    s_waitcnt vmcnt(7)
    s_waitcnt lgkmcnt(0)
    s_barrier
    ds_read_b64_tr_b16 a[224:225], v15 offset:36864
    ds_read_b64_tr_b16 a[226:227], v15 offset:37376
    ds_read_b64_tr_b16 a[228:229], v16 offset:36864
    v_mov_b32 v34, 0
    v_lshlrev_b32 v224, 4, v0
    ds_read_b128 v[128:131], v224 offset:49152
    ds_read_b128 v[132:135], v224 offset:53248
    ds_read_b128 v[136:139], v224 offset:57344
    ds_read_b128 v[140:143], v224 offset:61440
    v_mfma_f32_32x32x16_bf16 v[80:95], a[244:247], a[24:27], v[80:95]
    ds_read_b64_tr_b16 a[230:231], v16 offset:37376
    ds_read_b64_tr_b16 a[232:233], v15 offset:38912
    ds_read_b64_tr_b16 a[234:235], v15 offset:39424
    v_mfma_f32_32x32x16_bf16 v[64:79], a[216:219], a[28:31], v[64:79]
    ds_read_b64_tr_b16 v[48:49], v21 offset:36864
    ds_read_b64_tr_b16 v[50:51], v21 offset:37376
    ds_read_b64_tr_b16 v[52:53], v22 offset:36864
    ds_read_b64_tr_b16 v[54:55], v22 offset:37376
    v_lshrrev_b32 v224, 5, v0
    v_and_b32 v225, 31, v0
    v_lshlrev_b32 v225, 4, v225
    v_lshl_add_u32 v224, v224, 13, v225
    s_lshl_b32 s60, s35, 18
    s_lshl_b32 s54, s34, 9
    s_add_u32 s60, s60, s54
    s_add_u32 s60, s60, 1048576
    s_waitcnt lgkmcnt(7)
    buffer_store_dwordx4 v[128:131], v224, s[16:19], s60 offen sc1
    s_add_u32 s60, s60, 65536
    buffer_store_dwordx4 v[132:135], v224, s[16:19], s60 offen sc1
    s_add_u32 s60, s60, 65536
    buffer_store_dwordx4 v[136:139], v224, s[16:19], s60 offen sc1
    s_add_u32 s60, s60, 65536
    buffer_store_dwordx4 v[140:143], v224, s[16:19], s60 offen sc1
    v_mfma_f32_32x32x16_bf16 v[80:95], a[220:223], a[28:31], v[80:95]
    s_add_u32 m0, s62, 102400
    s_add_u32 s51, s3, 384
    s_and_b32 s51, s51, 0x380
    s_mul_i32 s51, s51, 1792
    buffer_load_dwordx4 v6, s[8:11], s51 offen offset:0  lds
    ds_read_b64_tr_b16 a[236:237], v16 offset:38912
    ds_read_b64_tr_b16 a[238:239], v16 offset:39424
    v_mfma_f32_32x32x16_bf16 v[64:79], a[224:227], a[32:35], v[64:79]
    ds_read_b64_tr_b16 a[240:241], v15 offset:40960
    ds_read_b64_tr_b16 a[242:243], v15 offset:41472
    ds_read_b64_tr_b16 a[244:245], v16 offset:40960
    v_mov_b32 v35, 0
    s_waitcnt lgkmcnt(11)
    v_mfma_f32_32x32x16_bf16 v[80:95], a[228:231], a[32:35], v[80:95]
    buffer_load_dwordx4 v7, s[8:11], s51 offen offset:1024  lds
    ds_read_b64_tr_b16 a[246:247], v16 offset:41472
    ds_read_b64_tr_b16 a[216:217], v15 offset:43008
    s_waitcnt lgkmcnt(7)
    v_mfma_f32_4x4x4_16b_bf16 v[40:43], v[56:57], v[48:49], v[40:43]
    v_mfma_f32_4x4x4_16b_bf16 v[44:47], v[56:57], v[52:53], v[44:47]
    s_nop 0
    v_mfma_f32_4x4x4_16b_bf16 v[40:43], v[56:57], v[50:51], v[40:43]
    v_mfma_f32_4x4x4_16b_bf16 v[44:47], v[56:57], v[54:55], v[44:47]
    v_mfma_f32_32x32x16_bf16 v[64:79], a[232:235], a[36:39], v[64:79]
    ds_read_b64_tr_b16 a[218:219], v15 offset:43520
    ds_read_b64_tr_b16 a[220:221], v16 offset:43008
    ds_read_b64_tr_b16 a[222:223], v16 offset:43520
    v_mov_b32 v38, 0
    s_waitcnt lgkmcnt(8)
    v_mfma_f32_32x32x16_bf16 v[80:95], a[236:239], a[36:39], v[80:95]
    v_mov_b32 v39, 0
    v_and_b32 v230, 31, v1
    v_or_b32 v231, s39, v230
    v_cmp_eq_u32 vcc, 0, v231
    v_lshlrev_b32 v230, 1, v230
    v_mov_b32 v231, 80
    v_cndmask_b32 v230, v230, v231, vcc
    v_lshrrev_b32 v231, 5, v1
    v_lshl_add_u32 v230, v231, 9, v230
    s_lshl_b32 s54, s38, 1
    s_and_b32 s54, s54, 15
    s_add_u32 s54, s54, s59
    v_add_u32 v116, s54, v230
    s_waitcnt lgkmcnt(6)
    v_mfma_f32_32x32x16_bf16 v[64:79], a[240:243], a[40:43], v[64:79]
    s_waitcnt vmcnt(11)
    s_barrier
    ds_read_b64_tr_b16 a[224:225], v15 offset:53248
    ds_read_b64_tr_b16 a[226:227], v15 offset:53760
    ds_read_b64_tr_b16 a[228:229], v16 offset:53248
    v_mov_b32 v240, 0
    v_mov_b32 v241, 0
    s_waitcnt lgkmcnt(7)
    v_mfma_f32_32x32x16_bf16 v[80:95], a[244:247], a[40:43], v[80:95]
    ds_read_b64_tr_b16 a[230:231], v16 offset:53760
    ds_read_b64_tr_b16 a[232:233], v15 offset:55296
    ds_read_b64_tr_b16 a[234:235], v15 offset:55808
    v_mov_b32 v242, 0
    v_mov_b32 v243, 0
    v_mov_b32 v244, 0
    v_mov_b32 v245, 0
    s_waitcnt lgkmcnt(8)
    v_mfma_f32_32x32x16_bf16 v[64:79], a[216:219], a[44:47], v[64:79]
    ds_read_b64_tr_b16 v[48:49], v21 offset:53248
    ds_read_b64_tr_b16 v[50:51], v21 offset:53760
    ds_read_b64_tr_b16 v[52:53], v22 offset:53248
    ds_read_b64_tr_b16 v[54:55], v22 offset:53760
    v_mov_b32 v246, 0
    v_mov_b32 v247, 0
    s_waitcnt lgkmcnt(10)
    v_mfma_f32_32x32x16_bf16 v[80:95], a[220:223], a[44:47], v[80:95]
    s_add_u32 m0, s62, 118784
    s_add_u32 s51, s3, 896
    s_and_b32 s51, s51, 0x380
    s_mul_i32 s51, s51, 1792
    buffer_load_dwordx4 v6, s[8:11], s51 offen offset:0  lds
    ds_read_b64_tr_b16 a[236:237], v16 offset:55296
    ds_read_b64_tr_b16 a[238:239], v16 offset:55808
    v_mov_b32 v248, 0
    s_waitcnt lgkmcnt(10)
    v_mfma_f32_32x32x16_bf16 v[64:79], a[224:227], a[48:51], v[64:79]
    ds_read_b64_tr_b16 a[240:241], v15 offset:57344
    ds_read_b64_tr_b16 a[242:243], v15 offset:57856
    ds_read_b64_tr_b16 a[244:245], v16 offset:57344
    v_mov_b32 v249, 0
    v_mov_b32 v250, 0
    v_mov_b32 v251, 0
    s_waitcnt lgkmcnt(11)
    v_mfma_f32_32x32x16_bf16 v[80:95], a[228:231], a[48:51], v[80:95]
    buffer_load_dwordx4 v7, s[8:11], s51 offen offset:1024  lds
    ds_read_b64_tr_b16 a[246:247], v16 offset:57856
    ds_read_b64_tr_b16 a[216:217], v15 offset:59392
    v_mov_b32 v252, 0
    s_waitcnt lgkmcnt(7)
    v_mfma_f32_4x4x4_16b_bf16 v[40:43], v[56:57], v[48:49], v[40:43]
    v_mfma_f32_4x4x4_16b_bf16 v[44:47], v[56:57], v[52:53], v[44:47]
    s_nop 0
    v_mfma_f32_4x4x4_16b_bf16 v[40:43], v[56:57], v[50:51], v[40:43]
    v_mfma_f32_4x4x4_16b_bf16 v[44:47], v[56:57], v[54:55], v[44:47]
    v_mfma_f32_32x32x16_bf16 v[64:79], a[232:235], a[52:55], v[64:79]
    ds_read_b64_tr_b16 a[218:219], v15 offset:59904
    ds_read_b64_tr_b16 a[220:221], v16 offset:59392
    ds_read_b64_tr_b16 a[222:223], v16 offset:59904
    v_mov_b32 v253, 0
    v_mov_b32 v254, 0
    v_mov_b32 v255, 0
    s_waitcnt lgkmcnt(8)
    v_mfma_f32_32x32x16_bf16 v[80:95], a[236:239], a[52:55], v[80:95]
    s_waitcnt lgkmcnt(6)
    v_mfma_f32_32x32x16_bf16 v[64:79], a[240:243], a[56:59], v[64:79]
    s_waitcnt vmcnt(10)
    s_barrier
    s_add_u32 m0, s47, 0
    s_lshl4_add_u32 s55, s79, s48
    buffer_load_dwordx4 v238, s[12:15], s55 offen lds
    ds_read_b64_tr_b16 a[224:225], v13 offset:32768
    ds_read_b64_tr_b16 a[226:227], v13 offset:33280
    s_waitcnt lgkmcnt(6)
    v_mfma_f32_32x32x16_bf16 v[80:95], a[244:247], a[56:59], v[80:95]
    ds_read_b64_tr_b16 a[228:229], v14 offset:32768
    ds_read_b64_tr_b16 a[230:231], v14 offset:33280
    ds_read_b64_tr_b16 a[232:233], v13 offset:34816
    s_waitcnt lgkmcnt(7)
    v_mfma_f32_32x32x16_bf16 v[64:79], a[216:219], a[60:63], v[64:79]
    buffer_load_dwordx4 v239, s[12:15], s55 offen offset:1024 lds
    ds_read_b64_tr_b16 v[48:49], v19 offset:32768
    ds_read_b64_tr_b16 v[50:51], v19 offset:33280
    ds_read_b64_tr_b16 v[52:53], v20 offset:32768
    ds_read_b64_tr_b16 v[54:55], v20 offset:33280
    s_waitcnt lgkmcnt(9)
    v_mfma_f32_32x32x16_bf16 v[80:95], a[220:223], a[60:63], v[80:95]
    ds_read_b64_tr_b16 a[234:235], v13 offset:35328
    ds_read_b64_tr_b16 a[236:237], v14 offset:34816
    ds_read_b64_tr_b16 a[238:239], v14 offset:35328
    s_waitcnt lgkmcnt(10)
    v_mfma_f32_32x32x16_bf16 v[64:79], a[224:227], a[64:67], v[64:79]
    ds_read_b64_tr_b16 a[240:241], v13 offset:36864
    ds_read_b64_tr_b16 a[242:243], v13 offset:37376
    ds_read_b64_tr_b16 a[244:245], v14 offset:36864
    s_waitcnt lgkmcnt(11)
    s_add_u32 m0, s47, 2048
    v_mfma_f32_32x32x16_bf16 v[80:95], a[228:231], a[64:67], v[80:95]
    s_lshl4_add_u32 s55, s80, s48
    buffer_load_dwordx4 v238, s[12:15], s55 offen lds
    ds_read_b64_tr_b16 a[246:247], v14 offset:37376
    ds_read_b64_tr_b16 a[216:217], v13 offset:38912
    s_waitcnt lgkmcnt(8)
    v_mfma_f32_4x4x4_16b_bf16 v[40:43], v[56:57], v[48:49], v[40:43]
    v_mfma_f32_4x4x4_16b_bf16 v[44:47], v[56:57], v[52:53], v[44:47]
    s_nop 0
    v_mfma_f32_4x4x4_16b_bf16 v[40:43], v[56:57], v[50:51], v[40:43]
    v_mfma_f32_4x4x4_16b_bf16 v[44:47], v[56:57], v[54:55], v[44:47]
    s_waitcnt lgkmcnt(7)
    v_mfma_f32_32x32x16_bf16 v[64:79], a[232:235], a[68:71], v[64:79]
    ds_read_b64_tr_b16 a[218:219], v13 offset:39424
    ds_read_b64_tr_b16 a[220:221], v14 offset:38912
    ds_read_b64_tr_b16 a[222:223], v14 offset:39424
    s_waitcnt vmcnt(7)
    s_lshl_b32 s60, s35, 10
    s_lshl_b32 s54, s33, 8
    s_add_u32 s60, s60, s54
    s_lshl_b32 s54, s34, 4
    s_add_u32 s60, s60, s54
    s_add_u32 s60, s60, 131072
    v_mov_b32 v62, 0
    v_mov_b32 v63, s32
    s_mov_b64 exec, 1
    buffer_store_dword v63, v62, s[16:19], s60 offen sc1
    s_mov_b64 exec, -1
    s_waitcnt lgkmcnt(8)
    v_mfma_f32_32x32x16_bf16 v[80:95], a[236:239], a[68:71], v[80:95]
    buffer_load_dwordx4 v239, s[12:15], s55 offen offset:1024 lds
    s_waitcnt lgkmcnt(6)
    v_mfma_f32_32x32x16_bf16 v[64:79], a[240:243], a[72:75], v[64:79]
    s_barrier
    ds_read_b64_tr_b16 a[224:225], v13 offset:40960
    ds_read_b64_tr_b16 a[226:227], v13 offset:41472
    ds_read_b64_tr_b16 a[228:229], v14 offset:40960
    s_waitcnt lgkmcnt(7)
    v_mfma_f32_32x32x16_bf16 v[80:95], a[244:247], a[72:75], v[80:95]
    ds_read_b64_tr_b16 a[230:231], v14 offset:41472
    ds_read_b64_tr_b16 a[232:233], v13 offset:43008
    ds_read_b64_tr_b16 a[234:235], v13 offset:43520
    s_waitcnt lgkmcnt(8)
    s_add_u32 m0, s47, 4096
    v_mfma_f32_32x32x16_bf16 v[64:79], a[216:219], a[76:79], v[64:79]
    s_lshl4_add_u32 s55, s81, s48
    buffer_load_dwordx4 v238, s[12:15], s55 offen lds
    ds_read_b64_tr_b16 v[48:49], v19 offset:40960
    ds_read_b64_tr_b16 v[50:51], v19 offset:41472
    ds_read_b64_tr_b16 v[52:53], v20 offset:40960
    ds_read_b64_tr_b16 v[54:55], v20 offset:41472
    s_waitcnt lgkmcnt(10)
    v_mfma_f32_32x32x16_bf16 v[80:95], a[220:223], a[76:79], v[80:95]
    ds_read_b64_tr_b16 a[236:237], v14 offset:43008
    ds_read_b64_tr_b16 a[238:239], v14 offset:43520
    ds_read_b64_tr_b16 a[240:241], v13 offset:45056
    s_waitcnt lgkmcnt(11)
    v_mfma_f32_32x32x16_bf16 v[64:79], a[224:227], a[80:83], v[64:79]
    buffer_load_dwordx4 v239, s[12:15], s55 offen offset:1024 lds
    ds_read_b64_tr_b16 a[242:243], v13 offset:45568
    ds_read_b64_tr_b16 a[244:245], v14 offset:45056
    s_waitcnt lgkmcnt(11)
    v_mfma_f32_32x32x16_bf16 v[80:95], a[228:231], a[80:83], v[80:95]
    ds_read_b64_tr_b16 a[246:247], v14 offset:45568
    ds_read_b64_tr_b16 a[216:217], v13 offset:47104
    ds_read_b64_tr_b16 a[218:219], v13 offset:47616
    s_waitcnt lgkmcnt(8)
    v_mfma_f32_4x4x4_16b_bf16 v[40:43], v[56:57], v[48:49], v[40:43]
    v_mfma_f32_4x4x4_16b_bf16 v[44:47], v[56:57], v[52:53], v[44:47]
    s_nop 0
    v_mfma_f32_4x4x4_16b_bf16 v[40:43], v[56:57], v[50:51], v[40:43]
    v_mfma_f32_4x4x4_16b_bf16 v[44:47], v[56:57], v[54:55], v[44:47]
    v_mfma_f32_32x32x16_bf16 v[64:79], a[232:235], a[84:87], v[64:79]
    ds_read_b64_tr_b16 a[220:221], v14 offset:47104
    ds_read_b64_tr_b16 a[222:223], v14 offset:47616
    s_waitcnt lgkmcnt(8)
    s_add_u32 m0, s47, 6144
    v_mfma_f32_32x32x16_bf16 v[80:95], a[236:239], a[84:87], v[80:95]
    s_lshl4_add_u32 s55, s82, s48
    buffer_load_dwordx4 v238, s[12:15], s55 offen lds
    s_waitcnt lgkmcnt(6)
    v_mfma_f32_32x32x16_bf16 v[64:79], a[240:243], a[88:91], v[64:79]
    s_waitcnt vmcnt(10)
    s_barrier
    ds_read_b64_tr_b16 a[224:225], v15 offset:4096
    ds_read_b64_tr_b16 a[226:227], v15 offset:4608
    ds_read_b64_tr_b16 a[228:229], v16 offset:4096
    s_waitcnt lgkmcnt(7)
    v_mfma_f32_32x32x16_bf16 v[80:95], a[244:247], a[88:91], v[80:95]
    ds_read_b64_tr_b16 a[230:231], v16 offset:4608
    ds_read_b64_tr_b16 a[232:233], v15 offset:6144
    ds_read_b64_tr_b16 a[234:235], v15 offset:6656
    s_waitcnt lgkmcnt(8)
    v_mfma_f32_32x32x16_bf16 v[64:79], a[216:219], a[92:95], v[64:79]
    buffer_load_dwordx4 v239, s[12:15], s55 offen offset:1024 lds
    ds_read_b64_tr_b16 v[48:49], v21 offset:4096
    ds_read_b64_tr_b16 v[50:51], v21 offset:4608
    ds_read_b64_tr_b16 v[52:53], v22 offset:4096
    ds_read_b64_tr_b16 v[54:55], v22 offset:4608
    s_waitcnt lgkmcnt(10)
    v_mfma_f32_32x32x16_bf16 v[80:95], a[220:223], a[92:95], v[80:95]
    ds_read_b64_tr_b16 a[236:237], v16 offset:6144
    ds_read_b64_tr_b16 a[238:239], v16 offset:6656
    ds_read_b64_tr_b16 a[240:241], v15 offset:8192
    s_waitcnt lgkmcnt(11)
    s_add_u32 m0, s62, 49152
    v_mfma_f32_32x32x16_bf16 v[64:79], a[224:227], a[96:99], v[64:79]
    s_lshl4_add_u32 s55, s83, s48
    buffer_load_dwordx4 v238, s[12:15], s55 offen lds
    ds_read_b64_tr_b16 a[242:243], v15 offset:8704
    ds_read_b64_tr_b16 a[244:245], v16 offset:8192
    s_waitcnt lgkmcnt(11)
    v_mfma_f32_32x32x16_bf16 v[80:95], a[228:231], a[96:99], v[80:95]
    ds_read_b64_tr_b16 a[246:247], v16 offset:8704
    ds_read_b64_tr_b16 a[216:217], v15 offset:10240
    ds_read_b64_tr_b16 a[218:219], v15 offset:10752
    s_waitcnt lgkmcnt(8)
    v_mfma_f32_4x4x4_16b_bf16 v[40:43], v[56:57], v[48:49], v[40:43]
    v_mfma_f32_4x4x4_16b_bf16 v[44:47], v[56:57], v[52:53], v[44:47]
    s_nop 0
    v_mfma_f32_4x4x4_16b_bf16 v[40:43], v[56:57], v[50:51], v[40:43]
    v_mfma_f32_4x4x4_16b_bf16 v[44:47], v[56:57], v[54:55], v[44:47]
    v_mfma_f32_32x32x16_bf16 v[64:79], a[232:235], a[100:103], v[64:79]
    ds_read_b64_tr_b16 a[220:221], v16 offset:10240
    ds_read_b64_tr_b16 a[222:223], v16 offset:10752
    s_waitcnt lgkmcnt(8)
    v_mfma_f32_32x32x16_bf16 v[80:95], a[236:239], a[100:103], v[80:95]
    buffer_load_dwordx4 v239, s[12:15], s55 offen offset:1024 lds
    s_waitcnt lgkmcnt(6)
    v_mfma_f32_32x32x16_bf16 v[64:79], a[240:243], a[104:107], v[64:79]
    s_waitcnt vmcnt(11)
    s_barrier
    ds_read_b64_tr_b16 a[224:225], v15 offset:20480
    ds_read_b64_tr_b16 a[226:227], v15 offset:20992
    ds_read_b64_tr_b16 a[228:229], v16 offset:20480
    s_waitcnt lgkmcnt(7)
    s_add_u32 m0, s62, 57344
    v_mfma_f32_32x32x16_bf16 v[80:95], a[244:247], a[104:107], v[80:95]
    s_lshl4_add_u32 s55, s84, s48
    buffer_load_dwordx4 v238, s[12:15], s55 offen lds
    ds_read_b64_tr_b16 a[230:231], v16 offset:20992
    ds_read_b64_tr_b16 a[232:233], v15 offset:22528
    s_waitcnt lgkmcnt(7)
    v_mfma_f32_32x32x16_bf16 v[64:79], a[216:219], a[108:111], v[64:79]
    ds_read_b64_tr_b16 v[48:49], v21 offset:20480
    ds_read_b64_tr_b16 v[50:51], v21 offset:20992
    ds_read_b64_tr_b16 v[52:53], v22 offset:20480
    ds_read_b64_tr_b16 v[54:55], v22 offset:20992
    ds_read_u16_d16_hi v240, v116 offset:0
    ds_read_u16_d16_hi v241, v116 offset:2048
    ds_read_u16_d16_hi v242, v116 offset:128
    ds_read_u16_d16_hi v243, v116 offset:2176
    ds_read_u16_d16_hi v244, v116 offset:256
    ds_read_u16_d16_hi v245, v116 offset:2304
    ds_read_u16_d16_hi v246, v116 offset:384
    ds_read_u16_d16_hi v247, v116 offset:2432
    ds_read_u16_d16_hi v248, v116 offset:1024
    ds_read_u16_d16_hi v249, v116 offset:3072
    ds_read_u16_d16_hi v250, v116 offset:1152
    ds_read_u16_d16_hi v251, v116 offset:3200
    ds_read_u16_d16_hi v252, v116 offset:1280
    ds_read_u16_d16_hi v253, v116 offset:3328
    ds_read_u16_d16_hi v254, v116 offset:1408
    ds_read_u16_d16_hi v255, v116 offset:3456
    s_waitcnt lgkmcnt(15)
    v_mfma_f32_32x32x16_bf16 v[80:95], a[220:223], a[108:111], v[80:95]
    ds_read_b64_tr_b16 a[234:235], v15 offset:23040
    ds_read_b64_tr_b16 a[236:237], v16 offset:22528
    ds_read_b64_tr_b16 a[238:239], v16 offset:23040
    v_mfma_f32_32x32x16_bf16 v[64:79], a[224:227], a[112:115], v[64:79]
    buffer_load_dwordx4 v239, s[12:15], s55 offen offset:1024 lds
    ds_read_b64_tr_b16 a[240:241], v15 offset:24576
    ds_read_b64_tr_b16 a[242:243], v15 offset:25088
    v_mfma_f32_4x4x4_16b_bf16 v[40:43], v[56:57], v[48:49], v[40:43]
    v_mfma_f32_4x4x4_16b_bf16 v[44:47], v[56:57], v[52:53], v[44:47]
    s_nop 0
    v_mfma_f32_4x4x4_16b_bf16 v[40:43], v[56:57], v[50:51], v[40:43]
    v_mfma_f32_4x4x4_16b_bf16 v[44:47], v[56:57], v[54:55], v[44:47]
    v_mfma_f32_32x32x16_bf16 v[80:95], a[228:231], a[112:115], v[80:95]
    ds_read_b64_tr_b16 a[244:245], v16 offset:24576
    ds_read_b64_tr_b16 a[246:247], v16 offset:25088
    ds_read_b64_tr_b16 a[216:217], v15 offset:26624
    s_lshl_b32 s60, s33, 2
    v_add_u32 v58, s60, v26
    ds_write_b32 v58, v40 offset:40960
    ds_write_b32 v58, v44 offset:41984
    s_waitcnt lgkmcnt(9)
    s_add_u32 m0, s62, 65536
    v_mfma_f32_32x32x16_bf16 v[64:79], a[232:235], a[116:119], v[64:79]
    s_lshl4_add_u32 s55, s85, s48
    buffer_load_dwordx4 v238, s[12:15], s55 offen lds
    ds_read_b64_tr_b16 a[218:219], v15 offset:27136
    ds_read_b64_tr_b16 a[220:221], v16 offset:26624
    s_waitcnt lgkmcnt(9)
    v_mfma_f32_32x32x16_bf16 v[80:95], a[236:239], a[116:119], v[80:95]
    s_waitcnt lgkmcnt(2)
    s_barrier
    ds_read_b64_tr_b16 a[222:223], v16 offset:27136
    ds_read_b128 v[40:43], v26 offset:40960
    ds_read_b128 v[44:47], v26 offset:41984
    v_mfma_f32_32x32x16_bf16 v[64:79], a[240:243], a[120:123], v[64:79]
    s_waitcnt lgkmcnt(0)
    v_add_f32 v40, v40, v41
    v_add_f32 v44, v44, v45
    v_add_f32 v42, v42, v43
    v_add_f32 v46, v46, v47
    v_add_f32 v40, v40, v42
    v_add_f32 v44, v44, v46
    v_mfma_f32_32x32x16_bf16 v[80:95], a[244:247], a[120:123], v[80:95]
    buffer_load_dwordx4 v239, s[12:15], s55 offen offset:1024 lds
    v_cvt_pk_bf16_f32 v33, v40, v40
    v_mfma_f32_32x32x16_bf16 v[64:79], a[216:219], a[124:127], v[64:79]
    v_cvt_pk_bf16_f32 v37, v44, v44
    v_and_b32 v41, 0xffff0000, v33
    v_and_b32 v45, 0xffff0000, v37
    v_sub_f32 v42, v40, v41
    v_sub_f32 v46, v44, v45
    v_cvt_pk_bf16_f32 v32, v41, v42
    v_cvt_pk_bf16_f32 v36, v45, v46
    v_mfma_f32_32x32x16_bf16 v[80:95], a[220:223], a[124:127], v[80:95]
    v_mfma_f32_32x32x16_bf16 v[64:79], v[32:35], v[28:31], v[64:79]
    v_mfma_f32_32x32x16_bf16 v[80:95], v[36:39], v[28:31], v[80:95]
    s_barrier
    s_add_u32 s53, s46, 4096
    v_mov_b32 v58, v23
    v_mov_b32 v59, v23
    v_mov_b32 v60, v24
    v_mov_b32 v61, v24
    s_nop 4
    v_pk_mul_f32 v[192:193], v[64:65], v[58:59]
    v_pk_mul_f32 v[194:195], v[66:67], v[58:59]
    v_exp_f32 v192, v192
    v_exp_f32 v193, v193
    v_exp_f32 v194, v194
    v_exp_f32 v195, v195
    v_pk_fma_f32 v[192:193], v[192:193], v[60:61], v[60:61]
    v_pk_fma_f32 v[194:195], v[194:195], v[60:61], v[60:61]
    v_rcp_f32 v192, v192
    v_rcp_f32 v193, v193
    v_rcp_f32 v194, v194
    v_rcp_f32 v195, v195
    v_pk_mul_f32 v[192:193], v[192:193], v[64:65]
    v_pk_mul_f32 v[194:195], v[194:195], v[66:67]
    v_cvt_pk_bf16_f32 v200, v192, v193
    v_cvt_pk_bf16_f32 v201, v194, v195
    v_pk_mul_f32 v[196:197], v[68:69], v[58:59]
    v_pk_mul_f32 v[198:199], v[70:71], v[58:59]
    v_exp_f32 v196, v196
    v_exp_f32 v197, v197
    v_exp_f32 v198, v198
    v_exp_f32 v199, v199
    v_pk_fma_f32 v[196:197], v[196:197], v[60:61], v[60:61]
    v_pk_fma_f32 v[198:199], v[198:199], v[60:61], v[60:61]
    v_rcp_f32 v196, v196
    v_rcp_f32 v197, v197
    v_rcp_f32 v198, v198
    v_rcp_f32 v199, v199
    v_pk_mul_f32 v[196:197], v[196:197], v[68:69]
    v_pk_mul_f32 v[198:199], v[198:199], v[70:71]
    v_cvt_pk_bf16_f32 v202, v196, v197
    v_cvt_pk_bf16_f32 v203, v198, v199
    buffer_store_dwordx4 v[200:203], v26, s[16:19], s46 offen offset:0 sc1
    v_pk_mul_f32 v[192:193], v[72:73], v[58:59]
    v_pk_mul_f32 v[194:195], v[74:75], v[58:59]
    v_exp_f32 v192, v192
    v_exp_f32 v193, v193
    v_exp_f32 v194, v194
    v_exp_f32 v195, v195
    v_pk_fma_f32 v[192:193], v[192:193], v[60:61], v[60:61]
    v_pk_fma_f32 v[194:195], v[194:195], v[60:61], v[60:61]
    v_rcp_f32 v192, v192
    v_rcp_f32 v193, v193
    v_rcp_f32 v194, v194
    v_rcp_f32 v195, v195
    v_pk_mul_f32 v[192:193], v[192:193], v[72:73]
    v_pk_mul_f32 v[194:195], v[194:195], v[74:75]
    v_cvt_pk_bf16_f32 v204, v192, v193
    v_cvt_pk_bf16_f32 v205, v194, v195
    v_pk_mul_f32 v[196:197], v[76:77], v[58:59]
    v_pk_mul_f32 v[198:199], v[78:79], v[58:59]
    v_exp_f32 v196, v196
    v_exp_f32 v197, v197
    v_exp_f32 v198, v198
    v_exp_f32 v199, v199
    v_pk_fma_f32 v[196:197], v[196:197], v[60:61], v[60:61]
    v_pk_fma_f32 v[198:199], v[198:199], v[60:61], v[60:61]
    v_rcp_f32 v196, v196
    v_rcp_f32 v197, v197
    v_rcp_f32 v198, v198
    v_rcp_f32 v199, v199
    v_pk_mul_f32 v[196:197], v[196:197], v[76:77]
    v_pk_mul_f32 v[198:199], v[198:199], v[78:79]
    v_cvt_pk_bf16_f32 v206, v196, v197
    v_cvt_pk_bf16_f32 v207, v198, v199
    buffer_store_dwordx4 v[204:207], v26, s[16:19], s46 offen offset:1024 sc1
    v_pk_mul_f32 v[192:193], v[80:81], v[58:59]
    v_pk_mul_f32 v[194:195], v[82:83], v[58:59]
    v_exp_f32 v192, v192
    v_exp_f32 v193, v193
    v_exp_f32 v194, v194
    v_exp_f32 v195, v195
    v_pk_fma_f32 v[192:193], v[192:193], v[60:61], v[60:61]
    v_pk_fma_f32 v[194:195], v[194:195], v[60:61], v[60:61]
    v_rcp_f32 v192, v192
    v_rcp_f32 v193, v193
    v_rcp_f32 v194, v194
    v_rcp_f32 v195, v195
    v_pk_mul_f32 v[192:193], v[192:193], v[80:81]
    v_pk_mul_f32 v[194:195], v[194:195], v[82:83]
    v_cvt_pk_bf16_f32 v200, v192, v193
    v_cvt_pk_bf16_f32 v201, v194, v195
    v_pk_mul_f32 v[196:197], v[84:85], v[58:59]
    v_pk_mul_f32 v[198:199], v[86:87], v[58:59]
    v_exp_f32 v196, v196
    v_exp_f32 v197, v197
    v_exp_f32 v198, v198
    v_exp_f32 v199, v199
    v_pk_fma_f32 v[196:197], v[196:197], v[60:61], v[60:61]
    v_pk_fma_f32 v[198:199], v[198:199], v[60:61], v[60:61]
    v_rcp_f32 v196, v196
    v_rcp_f32 v197, v197
    v_rcp_f32 v198, v198
    v_rcp_f32 v199, v199
    v_pk_mul_f32 v[196:197], v[196:197], v[84:85]
    v_pk_mul_f32 v[198:199], v[198:199], v[86:87]
    v_cvt_pk_bf16_f32 v202, v196, v197
    v_cvt_pk_bf16_f32 v203, v198, v199
    buffer_store_dwordx4 v[200:203], v26, s[16:19], s46 offen offset:2048 sc1
    v_pk_mul_f32 v[192:193], v[88:89], v[58:59]
    v_pk_mul_f32 v[194:195], v[90:91], v[58:59]
    v_exp_f32 v192, v192
    v_exp_f32 v193, v193
    v_exp_f32 v194, v194
    v_exp_f32 v195, v195
    v_pk_fma_f32 v[192:193], v[192:193], v[60:61], v[60:61]
    v_pk_fma_f32 v[194:195], v[194:195], v[60:61], v[60:61]
    v_rcp_f32 v192, v192
    v_rcp_f32 v193, v193
    v_rcp_f32 v194, v194
    v_rcp_f32 v195, v195
    v_pk_mul_f32 v[192:193], v[192:193], v[88:89]
    v_pk_mul_f32 v[194:195], v[194:195], v[90:91]
    v_cvt_pk_bf16_f32 v204, v192, v193
    v_cvt_pk_bf16_f32 v205, v194, v195
    v_pk_mul_f32 v[196:197], v[92:93], v[58:59]
    v_pk_mul_f32 v[198:199], v[94:95], v[58:59]
    v_exp_f32 v196, v196
    v_exp_f32 v197, v197
    v_exp_f32 v198, v198
    v_exp_f32 v199, v199
    v_pk_fma_f32 v[196:197], v[196:197], v[60:61], v[60:61]
    v_pk_fma_f32 v[198:199], v[198:199], v[60:61], v[60:61]
    v_rcp_f32 v196, v196
    s_lshr_b32 s60, s38, 1
    s_and_b32 s60, s60, 3
    s_lshl_b32 s60, s60, 8
    s_lshl_b32 s54, s39, 10
    s_add_u32 s60, s60, s54
    s_add_u32 s63, s60, 131072
    v_and_b32 v228, 15, v1
    v_lshlrev_b32 v228, 4, v228
    buffer_load_dword v229, v228, s[16:19], s63 offen sc1
    v_rcp_f32 v197, v197
    v_rcp_f32 v198, v198
    v_rcp_f32 v199, v199
    v_pk_mul_f32 v[196:197], v[196:197], v[92:93]
    v_pk_mul_f32 v[198:199], v[198:199], v[94:95]
    v_cvt_pk_bf16_f32 v206, v196, v197
    v_cvt_pk_bf16_f32 v207, v198, v199
    buffer_store_dwordx4 v[204:207], v26, s[16:19], s46 offen offset:3072 sc1
    v_bfe_u32 v208, v1, 4, 1
    v_bfe_u32 v209, v1, 3, 1
    s_add_u32 m0, s62, 73728
    s_lshl4_add_u32 s55, s76, s48
    buffer_load_dwordx4 v238, s[12:15], s55 offen lds
    v_bfe_u32 v210, v1, 2, 1
    v_bfe_u32 v211, v1, 1, 1
    v_lshl_add_u32 v212, v209, 1, v211
    v_lshl_add_u32 v212, v210, 2, v212
    v_lshl_add_u32 v212, v208, 3, v212
    s_lshl_b32 s98, s33, 4
    v_add_u32 v212, s98, v212
    v_and_b32 v213, 1, v1
    v_cvt_f32_u32 v216, v213
    v_mul_f32 v216, 0x3e800000, v216
    v_cvt_f32_u32 v217, v212
    v_mul_f32 v217, 0x3c800000, v217
    v_lshrrev_b32 v212, 5, v1
    v_lshlrev_b32 v212, 2, v212
    v_cvt_f32_u32 v212, v212
    v_fmac_f32 v216, v212, v217
    s_mov_b32 s98, 0x80008000
    v_mul_lo_u32 v214, v211, s98
    v_cos_f32 v218, v216
    v_sin_f32 v219, v216
    buffer_load_dwordx4 v239, s[12:15], s55 offen offset:1024 lds
    v_add_f32 v216, v216, v217
    v_cos_f32 v220, v216
    v_sin_f32 v221, v216
    v_add_f32 v216, v216, v217
    v_cvt_pk_bf16_f32 v222, v218, v219
    v_xor_b32 v223, v222, v214
    v_accvgpr_write_b32 a128, v222
    v_accvgpr_write_b32 a144, v223
    v_cos_f32 v218, v216
    v_sin_f32 v219, v216
    v_add_f32 v216, v216, v217
    v_cvt_pk_bf16_f32 v224, v220, v221
    v_xor_b32 v225, v224, v214
    v_accvgpr_write_b32 a129, v224
    v_accvgpr_write_b32 a145, v225
    v_cos_f32 v220, v216
    v_sin_f32 v221, v216
    v_fmac_f32 v216, 0x40a00000, v217
    v_cvt_pk_bf16_f32 v222, v218, v219
    v_xor_b32 v223, v222, v214
    s_add_u32 m0, s62, 81920
    s_lshl4_add_u32 s55, s77, s48
    buffer_load_dwordx4 v238, s[12:15], s55 offen lds
    v_accvgpr_write_b32 a130, v222
    v_accvgpr_write_b32 a146, v223
    v_cos_f32 v218, v216
    v_sin_f32 v219, v216
    v_add_f32 v216, v216, v217
    v_cvt_pk_bf16_f32 v224, v220, v221
    v_xor_b32 v225, v224, v214
    v_accvgpr_write_b32 a131, v224
    v_accvgpr_write_b32 a147, v225
    v_cos_f32 v220, v216
    v_sin_f32 v221, v216
    v_add_f32 v216, v216, v217
    v_cvt_pk_bf16_f32 v222, v218, v219
    v_xor_b32 v223, v222, v214
    v_accvgpr_write_b32 a132, v222
    v_accvgpr_write_b32 a148, v223
    v_cos_f32 v218, v216
    v_sin_f32 v219, v216
    v_add_f32 v216, v216, v217
    buffer_load_dwordx4 v239, s[12:15], s55 offen offset:1024 lds
    v_cvt_pk_bf16_f32 v224, v220, v221
    v_xor_b32 v225, v224, v214
    v_accvgpr_write_b32 a133, v224
    v_accvgpr_write_b32 a149, v225
    v_cos_f32 v220, v216
    v_sin_f32 v221, v216
    v_fmac_f32 v216, 0x40a00000, v217
    v_cvt_pk_bf16_f32 v222, v218, v219
    v_xor_b32 v223, v222, v214
    v_accvgpr_write_b32 a134, v222
    v_accvgpr_write_b32 a150, v223
    v_cos_f32 v218, v216
    v_sin_f32 v219, v216
    v_add_f32 v216, v216, v217
    v_cvt_pk_bf16_f32 v224, v220, v221
    v_xor_b32 v225, v224, v214
    v_accvgpr_write_b32 a135, v224
    v_accvgpr_write_b32 a151, v225
    v_cos_f32 v220, v216
    v_sin_f32 v221, v216
    s_add_u32 m0, s62, 90112
    s_lshl4_add_u32 s55, s78, s48
    buffer_load_dwordx4 v238, s[12:15], s55 offen lds
    v_add_f32 v216, v216, v217
    v_cvt_pk_bf16_f32 v222, v218, v219
    v_xor_b32 v223, v222, v214
    v_accvgpr_write_b32 a136, v222
    v_accvgpr_write_b32 a152, v223
    v_cos_f32 v218, v216
    v_sin_f32 v219, v216
    v_add_f32 v216, v216, v217
    v_cvt_pk_bf16_f32 v224, v220, v221
    v_xor_b32 v225, v224, v214
    v_accvgpr_write_b32 a137, v224
    v_accvgpr_write_b32 a153, v225
    v_cos_f32 v220, v216
    v_sin_f32 v221, v216
    v_fmac_f32 v216, 0x40a00000, v217
    v_cvt_pk_bf16_f32 v222, v218, v219
    v_xor_b32 v223, v222, v214
    v_accvgpr_write_b32 a138, v222
    v_accvgpr_write_b32 a154, v223
    v_cos_f32 v218, v216
    buffer_load_dwordx4 v239, s[12:15], s55 offen offset:1024 lds
    v_sin_f32 v219, v216
    v_add_f32 v216, v216, v217
    v_cvt_pk_bf16_f32 v224, v220, v221
    v_xor_b32 v225, v224, v214
    v_accvgpr_write_b32 a139, v224
    v_accvgpr_write_b32 a155, v225
    v_cos_f32 v220, v216
    v_sin_f32 v221, v216
    v_add_f32 v216, v216, v217
    v_cvt_pk_bf16_f32 v222, v218, v219
    v_xor_b32 v223, v222, v214
    v_accvgpr_write_b32 a140, v222
    v_accvgpr_write_b32 a156, v223
    v_cos_f32 v218, v216
    v_sin_f32 v219, v216
    v_add_f32 v216, v216, v217
    v_cvt_pk_bf16_f32 v224, v220, v221
    v_xor_b32 v225, v224, v214
    v_accvgpr_write_b32 a141, v224
    s_add_u32 m0, s56, 98304
    s_lshl4_add_u32 s55, s64, s48
    buffer_load_dwordx4 v238, s[12:15], s55 offen lds
    v_accvgpr_write_b32 a157, v225
    v_cos_f32 v220, v216
    v_sin_f32 v221, v216
    v_cvt_pk_bf16_f32 v222, v218, v219
    v_xor_b32 v223, v222, v214
    v_accvgpr_write_b32 a142, v222
    v_accvgpr_write_b32 a158, v223
    v_cvt_pk_bf16_f32 v224, v220, v221
    v_xor_b32 v225, v224, v214
    v_accvgpr_write_b32 a143, v224
    v_accvgpr_write_b32 a159, v225
    v_bfe_u32 v213, v1, 3, 2
    v_lshl_add_u32 v213, v213, 1, v210
    v_and_b32 v208, 1, v1
    v_lshl_add_u32 v213, v213, 1, v208
    s_mov_b32 s98, 0x80008000
    v_mul_lo_u32 v214, v208, s98
    s_lshl_b32 s98, s33, 4
    v_add_u32 v213, s98, v213
    v_cvt_f32_u32 v213, v213
    buffer_load_dwordx4 v239, s[12:15], s55 offen offset:1024 lds
    v_mul_f32 v217, 0x3c800000, v213
    v_cvt_f32_u32 v216, v211
    v_mul_f32 v216, 0xbe800000, v216
    v_cvt_f32_u32 v208, s38
    v_mul_f32 v208, 0x3a000000, v208
    v_fmac_f32 v216, v208, v213
    v_fmac_f32 v216, v212, v217
    v_cos_f32 v218, v216
    v_sin_f32 v219, v216
    v_add_f32 v216, v216, v217
    v_cos_f32 v220, v216
    v_sin_f32 v221, v216
    v_add_f32 v216, v216, v217
    v_cvt_pk_bf16_f32 v222, v218, -v219
    s_waitcnt vmcnt(9)
    v_cmp_ne_u32 vcc, s32, v229
    s_nop 1
    s_cbranch_vccnz L_again_17
L_back_18:
    s_add_u32 m0, s62, 32768
    s_lshl_b32 s60, s39, 5
    s_add_u32 s60, s60, s38
    s_lshl_b32 s60, s60, 13
    s_add_u32 s60, s60, s62
    s_add_u32 s60, s60, 1048576
    buffer_load_dwordx4 v26, s[16:19], s60 offen offset:0 sc1 lds
    buffer_load_dwordx4 v26, s[16:19], s60 offen offset:1024 sc1 lds
    v_xor_b32 v223, v222, v214
    v_accvgpr_write_b32 a160, v222
    v_accvgpr_write_b32 a176, v223
    v_cos_f32 v218, v216
    v_sin_f32 v219, v216
    v_add_f32 v216, v216, v217
    s_add_u32 m0, s56, 100352
    s_lshl4_add_u32 s55, s65, s48
    buffer_load_dwordx4 v238, s[12:15], s55 offen lds
    v_cvt_pk_bf16_f32 v224, v220, -v221
    v_xor_b32 v225, v224, v214
    v_accvgpr_write_b32 a161, v224
    v_accvgpr_write_b32 a177, v225
    v_cos_f32 v220, v216
    v_sin_f32 v221, v216
    v_fmac_f32 v216, 0x40a00000, v217
    v_cvt_pk_bf16_f32 v222, v218, -v219
    v_xor_b32 v223, v222, v214
    v_accvgpr_write_b32 a162, v222
    v_accvgpr_write_b32 a178, v223
    v_cos_f32 v218, v216
    v_sin_f32 v219, v216
    v_add_f32 v216, v216, v217
    v_cvt_pk_bf16_f32 v224, v220, -v221
    v_xor_b32 v225, v224, v214
    v_accvgpr_write_b32 a163, v224
    v_accvgpr_write_b32 a179, v225
    v_cos_f32 v220, v216
    v_sin_f32 v221, v216
    buffer_load_dwordx4 v239, s[12:15], s55 offen offset:1024 lds
    v_add_f32 v216, v216, v217
    v_cvt_pk_bf16_f32 v222, v218, -v219
    v_xor_b32 v223, v222, v214
    v_accvgpr_write_b32 a164, v222
    v_accvgpr_write_b32 a180, v223
    v_cos_f32 v218, v216
    v_sin_f32 v219, v216
    v_add_f32 v216, v216, v217
    v_cvt_pk_bf16_f32 v224, v220, -v221
    v_xor_b32 v225, v224, v214
    v_accvgpr_write_b32 a165, v224
    v_accvgpr_write_b32 a181, v225
    v_cos_f32 v220, v216
    v_sin_f32 v221, v216
    v_fmac_f32 v216, 0x40a00000, v217
    v_cvt_pk_bf16_f32 v222, v218, -v219
    v_xor_b32 v223, v222, v214
    v_accvgpr_write_b32 a166, v222
    v_accvgpr_write_b32 a182, v223
    s_add_u32 m0, s56, 102400
    s_lshl4_add_u32 s55, s66, s48
    buffer_load_dwordx4 v238, s[12:15], s55 offen lds
    v_cos_f32 v218, v216
    v_sin_f32 v219, v216
    v_add_f32 v216, v216, v217
    v_cvt_pk_bf16_f32 v224, v220, -v221
    v_xor_b32 v225, v224, v214
    v_accvgpr_write_b32 a167, v224
    v_accvgpr_write_b32 a183, v225
    v_cos_f32 v220, v216
    v_sin_f32 v221, v216
    v_add_f32 v216, v216, v217
    v_cvt_pk_bf16_f32 v222, v218, -v219
    v_xor_b32 v223, v222, v214
    v_accvgpr_write_b32 a168, v222
    v_accvgpr_write_b32 a184, v223
    v_cos_f32 v218, v216
    v_sin_f32 v219, v216
    v_add_f32 v216, v216, v217
    v_cvt_pk_bf16_f32 v224, v220, -v221
    v_xor_b32 v225, v224, v214
    v_accvgpr_write_b32 a169, v224
    buffer_load_dwordx4 v239, s[12:15], s55 offen offset:1024 lds
    v_accvgpr_write_b32 a185, v225
    v_cos_f32 v220, v216
    v_sin_f32 v221, v216
    v_fmac_f32 v216, 0x40a00000, v217
    v_cvt_pk_bf16_f32 v222, v218, -v219
    v_xor_b32 v223, v222, v214
    v_accvgpr_write_b32 a170, v222
    v_accvgpr_write_b32 a186, v223
    v_cos_f32 v218, v216
    v_sin_f32 v219, v216
    v_add_f32 v216, v216, v217
    v_cvt_pk_bf16_f32 v224, v220, -v221
    v_xor_b32 v225, v224, v214
    v_accvgpr_write_b32 a171, v224
    v_accvgpr_write_b32 a187, v225
    v_cos_f32 v220, v216
    v_sin_f32 v221, v216
    s_lshl_b32 s50, s34, 1
    s_lshr_b32 s51, s33, 1
    s_add_u32 s50, s50, s51
    s_lshl_b32 s50, s50, 2
    s_lshr_b32 s51, s35, 1
    s_add_u32 s50, s50, s51
    s_lshl_b32 s50, s50, 3
    s_lshl_b32 s51, s36, 2
    s_add_u32 s50, s50, s51
    s_and_b32 s51, s35, 1
    s_lshl_b32 s51, s51, 1
    s_add_u32 s50, s50, s51
    s_and_b32 s51, s33, 1
    s_add_u32 s50, s50, s51
    s_lshl_b32 s50, s50, 4
    s_add_u32 s50, s50, 147456
    s_waitcnt vmcnt(14)
    v_mov_b32 v62, 0
    v_mov_b32 v63, s32
    s_mov_b64 exec, 1
    buffer_store_dword v63, v62, s[16:19], s50 offen sc1
    s_mov_b64 exec, -1
    v_add_f32 v216, v216, v217
    v_cvt_pk_bf16_f32 v222, v218, -v219
    v_xor_b32 v223, v222, v214
    s_add_u32 m0, s56, 104448
    s_lshl4_add_u32 s55, s67, s48
    buffer_load_dwordx4 v238, s[12:15], s55 offen lds
    v_accvgpr_write_b32 a172, v222
    v_accvgpr_write_b32 a188, v223
    v_cos_f32 v218, v216
    v_sin_f32 v219, v216
    v_add_f32 v216, v216, v217
    v_cvt_pk_bf16_f32 v224, v220, -v221
    v_xor_b32 v225, v224, v214
    v_accvgpr_write_b32 a173, v224
    v_accvgpr_write_b32 a189, v225
    v_cos_f32 v220, v216
    v_sin_f32 v221, v216
    v_cvt_pk_bf16_f32 v222, v218, -v219
    v_xor_b32 v223, v222, v214
    v_accvgpr_write_b32 a174, v222
    v_accvgpr_write_b32 a190, v223
    v_cvt_pk_bf16_f32 v224, v220, -v221
    v_xor_b32 v225, v224, v214
    v_accvgpr_write_b32 a175, v224
    v_accvgpr_write_b32 a191, v225
    buffer_load_dwordx4 v239, s[12:15], s55 offen offset:1024 lds
    v_lshrrev_b32 v62, 5, v1
    v_bfe_u32 v61, v1, 2, 2
    v_lshl_add_u32 v61, v62, 2, v61
    v_and_b32 v63, 3, v1
    v_lshlrev_b32 v63, 3, v63
    v_and_b32 v62, 16, v1
    v_lshl_add_u32 v63, v62, 1, v63
    v_lshl_add_u32 v63, v61, 7, v63
    v_and_b32 v62, 8, v1
    v_lshl_add_u32 v63, v62, 3, v63
    s_add_u32 s97, s47, 0
    v_add_u32 v9, s97, v63
    v_xor_b32 v10, 64, v9
    s_add_u32 s97, s62, 49152
    v_add_u32 v11, s97, v63
    v_xor_b32 v12, 64, v11
    s_add_u32 s97, s56, 98304
    v_add_u32 v13, s97, v63
    v_xor_b32 v14, 64, v13
    s_waitcnt vmcnt(7)
    s_barrier
    ds_read_b128 a[192:195], v26 offset:32768
    ds_read_b128 a[196:199], v26 offset:33792
    ds_read_b128 a[200:203], v26 offset:34816
    ds_read_b128 a[204:207], v26 offset:35840
    ds_read_b128 a[208:211], v26 offset:36864
    ds_read_b128 a[212:215], v26 offset:37888
    ds_read_b128 a[216:219], v26 offset:38912
    ds_read_b128 a[220:223], v26 offset:39936
    s_waitcnt lgkmcnt(7)
    s_add_u32 m0, s56, 106496
    v_mfma_f32_32x32x16_bf16 v[64:79], a[128:131], a[192:195], 0
    s_lshl4_add_u32 s55, s68, s48
    buffer_load_dwordx4 v238, s[12:15], s55 offen lds
    s_waitcnt lgkmcnt(6)
    v_mfma_f32_32x32x16_bf16 v[64:79], a[132:135], a[196:199], v[64:79]
    buffer_load_dwordx4 v239, s[12:15], s55 offen offset:1024 lds
    s_waitcnt lgkmcnt(5)
    s_add_u32 m0, s56, 108544
    v_mfma_f32_32x32x16_bf16 v[64:79], a[136:139], a[200:203], v[64:79]
    s_lshl4_add_u32 s55, s69, s48
    buffer_load_dwordx4 v238, s[12:15], s55 offen lds
    s_waitcnt lgkmcnt(4)
    v_mfma_f32_32x32x16_bf16 v[64:79], a[140:143], a[204:207], v[64:79]
    buffer_load_dwordx4 v239, s[12:15], s55 offen offset:1024 lds
    s_waitcnt lgkmcnt(3)
    s_add_u32 m0, s56, 110592
    v_mfma_f32_32x32x16_bf16 v[64:79], a[144:147], a[208:211], v[64:79]
    s_lshl4_add_u32 s55, s70, s48
    buffer_load_dwordx4 v238, s[12:15], s55 offen lds
    ds_read_b64_tr_b16 a[24:25], v9 offset:0
    ds_read_b64_tr_b16 a[26:27], v9 offset:1024
    ds_read_b64_tr_b16 a[28:29], v10 offset:0
    ds_read_b64_tr_b16 a[30:31], v10 offset:1024
    s_waitcnt lgkmcnt(6)
    v_mfma_f32_32x32x16_bf16 v[64:79], a[148:151], a[212:215], v[64:79]
    buffer_load_dwordx4 v239, s[12:15], s55 offen offset:1024 lds
    ds_read_b64_tr_b16 a[32:33], v9 offset:2048
    ds_read_b64_tr_b16 a[34:35], v9 offset:3072
    ds_read_b64_tr_b16 a[36:37], v10 offset:2048
    ds_read_b64_tr_b16 a[38:39], v10 offset:3072
    s_waitcnt lgkmcnt(9)
    s_add_u32 m0, s56, 112640
    v_mfma_f32_32x32x16_bf16 v[64:79], a[152:155], a[216:219], v[64:79]
    s_lshl4_add_u32 s55, s71, s48
    buffer_load_dwordx4 v238, s[12:15], s55 offen lds
    ds_read_b64_tr_b16 a[40:41], v9 offset:4096
    ds_read_b64_tr_b16 a[42:43], v9 offset:5120
    ds_read_b64_tr_b16 a[44:45], v10 offset:4096
    ds_read_b64_tr_b16 a[46:47], v10 offset:5120
    s_waitcnt lgkmcnt(12)
    v_mfma_f32_32x32x16_bf16 v[64:79], a[156:159], a[220:223], v[64:79]
    buffer_load_dwordx4 v239, s[12:15], s55 offen offset:1024 lds
    ds_read_b64_tr_b16 a[48:49], v9 offset:6144
    ds_read_b64_tr_b16 a[50:51], v9 offset:7168
    ds_read_b64_tr_b16 a[52:53], v10 offset:6144
    ds_read_b64_tr_b16 a[54:55], v10 offset:7168
    v_add_u32 v58, s62, v26
    s_nop 5
    v_mul_f32 v80, v64, v240
    v_mul_f32 v82, v66, v242
    v_mul_f32 v81, v64, v241
    v_mul_f32 v83, v66, v243
    v_fma_f32 v80, -v65, v241, v80
    v_fma_f32 v82, -v67, v243, v82
    v_fmac_f32 v81, v65, v240
    v_fmac_f32 v83, v67, v242
    v_cvt_pk_bf16_f32 v96, v80, v81
    v_cvt_pk_bf16_f32 v97, v82, v83
    v_mul_f32 v84, v68, v244
    v_mul_f32 v86, v70, v246
    v_mul_f32 v85, v68, v245
    v_mul_f32 v87, v70, v247
    v_fma_f32 v84, -v69, v245, v84
    v_fma_f32 v86, -v71, v247, v86
    v_fmac_f32 v85, v69, v244
    v_fmac_f32 v87, v71, v246
    v_cvt_pk_bf16_f32 v98, v84, v85
    v_cvt_pk_bf16_f32 v99, v86, v87
    v_mul_f32 v88, v72, v248
    v_mul_f32 v90, v74, v250
    v_mul_f32 v89, v72, v249
    v_mul_f32 v91, v74, v251
    v_fma_f32 v88, -v73, v249, v88
    v_fma_f32 v90, -v75, v251, v90
    v_fmac_f32 v89, v73, v248
    v_fmac_f32 v91, v75, v250
    v_cvt_pk_bf16_f32 v100, v88, v89
    v_cvt_pk_bf16_f32 v101, v90, v91
    ds_write_b128 v58, v[96:99] offset:40960
    v_mul_f32 v92, v76, v252
    v_mul_f32 v94, v78, v254
    v_mul_f32 v93, v76, v253
    v_mul_f32 v95, v78, v255
    v_fma_f32 v92, -v77, v253, v92
    v_fma_f32 v94, -v79, v255, v94
    v_fmac_f32 v93, v77, v252
    v_fmac_f32 v95, v79, v254
    v_cvt_pk_bf16_f32 v102, v92, v93
    v_cvt_pk_bf16_f32 v103, v94, v95
    ds_write_b128 v58, v[100:103] offset:41984
    s_waitcnt lgkmcnt(0)
    s_barrier
    ds_read_b128 a[192:195], v26 offset:40960
    ds_read_b128 a[196:199], v26 offset:41984
    ds_read_b128 a[200:203], v26 offset:43008
    ds_read_b128 a[204:207], v26 offset:44032
    ds_read_b128 a[208:211], v26 offset:45056
    ds_read_b128 a[212:215], v26 offset:46080
    ds_read_b128 a[216:219], v26 offset:47104
    ds_read_b128 a[220:223], v26 offset:48128
    s_lshl_b32 s50, s40, 2
    s_add_u32 s50, s50, s33
    s_lshl_b32 s50, s50, 7
    s_add_u32 s58, s50, 147456
    v_and_b32 v6, 7, v1
    v_lshlrev_b32 v6, 4, v6
    v_lshrrev_b32 v59, 4, v1
    s_waitcnt lgkmcnt(7)
    s_add_u32 m0, s47, 0
    v_mfma_f32_32x32x16_bf16 v[64:79], a[160:163], a[192:195], 0
    s_lshl4_add_u32 s55, s72, s48
    buffer_load_dwordx4 v238, s[12:15], s55 offen lds
    v_bfe_u32 v60, v1, 3, 1
    v_lshlrev_b32 v60, 12, v60
    s_waitcnt lgkmcnt(6)
    v_mfma_f32_32x32x16_bf16 v[64:79], a[164:167], a[196:199], v[64:79]
    buffer_load_dwordx4 v239, s[12:15], s55 offen offset:1024 lds
    v_lshl_add_u32 v60, v59, 16, v60
    v_and_b32 v61, 15, v1
    s_waitcnt lgkmcnt(5)
    v_mfma_f32_32x32x16_bf16 v[64:79], a[168:171], a[200:203], v[64:79]
    v_lshlrev_b32 v61, 2, v61
    v_lshl_add_u32 v61, v59, 7, v61
    s_waitcnt lgkmcnt(4)
    v_mfma_f32_32x32x16_bf16 v[64:79], a[172:175], a[204:207], v[64:79]
    v_add_u32 v61, s62, v61
    v_and_b32 v59, 7, v1
    s_waitcnt lgkmcnt(3)
    v_mfma_f32_32x32x16_bf16 v[64:79], a[176:179], a[208:211], v[64:79]
    v_lshl_add_u32 v59, v59, 4, v60
    s_lshl_b32 s51, s33, 19
    s_waitcnt lgkmcnt(2)
    v_mfma_f32_32x32x16_bf16 v[64:79], a[180:183], a[212:215], v[64:79]
    s_lshl_b32 s52, s38, 7
    s_add_u32 s51, s51, s52
    s_waitcnt lgkmcnt(1)
    v_mfma_f32_32x32x16_bf16 v[64:79], a[184:187], a[216:219], v[64:79]
    s_lshl_b32 s52, s39, 13
    s_add_u32 s51, s51, s52
    s_waitcnt lgkmcnt(0)
    v_mfma_f32_32x32x16_bf16 v[64:79], a[188:191], a[220:223], v[64:79]
    s_add_u32 s51, s51, 3145728
    s_add_u32 s52, s51, 262144
    s_nop 9
    v_cvt_pk_bf16_f32 v96, v64, v65
    v_cvt_pk_bf16_f32 v97, v66, v67
    v_cvt_pk_bf16_f32 v98, v68, v69
    v_cvt_pk_bf16_f32 v99, v70, v71
    v_cvt_pk_bf16_f32 v100, v72, v73
    v_cvt_pk_bf16_f32 v101, v74, v75
    v_cvt_pk_bf16_f32 v102, v76, v77
    v_cvt_pk_bf16_f32 v103, v78, v79
    ds_write_b32 v61, v96 offset:32768
    ds_write_b32 v61, v97 offset:32832
    ds_write_b32 v61, v98 offset:33280
    ds_write_b32 v61, v99 offset:33344
    ds_write_b32 v61, v100 offset:33792
    ds_write_b32 v61, v101 offset:33856
    ds_write_b32 v61, v102 offset:34304
    ds_write_b32 v61, v103 offset:34368
    s_waitcnt lgkmcnt(0)
    ds_read_b128 v[64:67], v58 offset:32768
    ds_read_b128 v[68:71], v58 offset:33792
    s_waitcnt lgkmcnt(0)
    buffer_store_dwordx4 v[64:67], v59, s[16:19], s51 offen sc1
    buffer_store_dwordx4 v[68:71], v59, s[16:19], s52 offen sc1
    buffer_load_dword v7, v6, s[16:19], s58 offen sc1
    s_mul_i32 s50, s40, 229376
    s_add_u32 s50, s50, 5242880
    v_add_u32 v19, s50, v26
    v_add_u32 v20, 114688, v19
    ds_read_b64_tr_b16 a[56:57], v11 offset:0
    ds_read_b64_tr_b16 a[58:59], v11 offset:1024
    ds_read_b64_tr_b16 a[60:61], v12 offset:0
    ds_read_b64_tr_b16 a[62:63], v12 offset:1024
    s_add_u32 m0, s47, 2048
    s_lshl4_add_u32 s55, s73, s48
    buffer_load_dwordx4 v238, s[12:15], s55 offen lds
    ds_read_b64_tr_b16 a[64:65], v11 offset:8192
    ds_read_b64_tr_b16 a[66:67], v11 offset:9216
    ds_read_b64_tr_b16 a[68:69], v12 offset:8192
    ds_read_b64_tr_b16 a[70:71], v12 offset:9216
    buffer_load_dwordx4 v239, s[12:15], s55 offen offset:1024 lds
    ds_read_b64_tr_b16 a[72:73], v11 offset:16384
    ds_read_b64_tr_b16 a[74:75], v11 offset:17408
    ds_read_b64_tr_b16 a[76:77], v12 offset:16384
    ds_read_b64_tr_b16 a[78:79], v12 offset:17408
    s_waitcnt lgkmcnt(8)
    s_add_u32 m0, s47, 4096
    s_lshl4_add_u32 s55, s74, s48
    buffer_load_dwordx4 v238, s[12:15], s55 offen lds
    ds_read_b64_tr_b16 a[0:1], v11 offset:24576
    ds_read_b64_tr_b16 a[2:3], v11 offset:25600
    ds_read_b64_tr_b16 a[4:5], v12 offset:24576
    ds_read_b64_tr_b16 a[6:7], v12 offset:25600
    s_waitcnt lgkmcnt(8)
    buffer_load_dwordx4 v239, s[12:15], s55 offen offset:1024 lds
    ds_read_b64_tr_b16 a[8:9], v11 offset:32768
    ds_read_b64_tr_b16 a[10:11], v11 offset:33792
    ds_read_b64_tr_b16 a[12:13], v12 offset:32768
    ds_read_b64_tr_b16 a[14:15], v12 offset:33792
    s_waitcnt lgkmcnt(8)
    s_add_u32 m0, s47, 6144
    s_lshl4_add_u32 s55, s75, s48
    buffer_load_dwordx4 v238, s[12:15], s55 offen lds
    ds_read_b64_tr_b16 a[16:17], v11 offset:40960
    ds_read_b64_tr_b16 a[18:19], v11 offset:41984
    ds_read_b64_tr_b16 a[20:21], v12 offset:40960
    ds_read_b64_tr_b16 a[22:23], v12 offset:41984
    s_waitcnt lgkmcnt(8)
    buffer_load_dwordx4 v239, s[12:15], s55 offen offset:1024 lds
    v_mov_b32 v2, v238
    v_mov_b32 v3, v239
    s_waitcnt vmcnt(6)
    v_cmp_ne_u32 vcc, s32, v7
    s_nop 1
    s_cbranch_vccnz L_again_20
L_back_21:
    s_lshl_b32 s50, s33, 3
    s_add_u32 s50, s50, s39
    s_lshl_b32 s50, s50, 5
    s_add_u32 s50, s50, s38
    s_lshl_b32 s50, s50, 4
    s_add_u32 s50, s50, 163840
L_join:
    v_mov_b32 v62, 0
    v_mov_b32 v63, s32
    s_mov_b64 exec, 1
    buffer_store_dword v63, v62, s[16:19], s50 offen sc1
    s_mov_b64 exec, -1
    buffer_load_dwordx4 a[192:195], v19, s[16:19], s64 offen sc1
    buffer_load_dwordx4 a[196:199], v20, s[16:19], s64 offen sc1
    buffer_load_dwordx4 a[200:203], v19, s[16:19], s65 offen sc1
    buffer_load_dwordx4 a[204:207], v20, s[16:19], s65 offen sc1
    buffer_load_dwordx4 a[208:211], v19, s[16:19], s66 offen sc1
    buffer_load_dwordx4 a[212:215], v20, s[16:19], s66 offen sc1
    buffer_load_dwordx4 a[216:219], v19, s[16:19], s67 offen sc1
    buffer_load_dwordx4 a[220:223], v20, s[16:19], s67 offen sc1
    v_and_b32 v40, 31, v1
    s_lshl_b32 s60, s41, 6
    s_add_u32 s60, s60, 0
    v_add_u32 v40, s60, v40
    v_lshrrev_b32 v43, 5, v1
    v_lshlrev_b32 v43, 1, v43
    s_lshl_b32 s60, s33, 6
    v_add_u32 v43, s60, v43
    v_cmp_eq_u32 s[96:97], 0, v43
    v_mul_u32_u24 v43, v43, v40
    v_and_b32 v43, 511, v43
    v_cvt_f32_u32 v42, v43
    v_mul_f32 v42, 0x3b000000, v42
    v_cvt_f32_u32 v41, v40
    v_and_b32 v43, 1, v40
    v_lshlrev_b32 v43, 15, v43
    v_xor_b32 v122, 0x3f80, v43
    v_mul_f32 v43, 0x3c800000, v41
    v_mul_f32 v41, 0x3b000000, v41
    v_cos_f32 v112, v43
    v_sin_f32 v113, v43
    v_cos_f32 v104, v42
    v_sin_f32 v105, v42
    v_add_f32 v42, v42, v41
    v_cos_f32 v106, v42
    v_sin_f32 v107, v42
    v_fmac_f32 v42, 0x40400000, v41
    v_cos_f32 v108, v42
    v_sin_f32 v109, v42
    v_add_f32 v42, v42, v41
    v_cos_f32 v110, v42
    v_sin_f32 v111, v42
    v_cvt_pk_bf16_f32 v128, v104, -v105
    v_cvt_pk_bf16_f32 v129, v106, -v107
    v_cvt_pk_bf16_f32 v130, v108, -v109
    v_cvt_pk_bf16_f32 v131, v110, -v111
    v_pk_mul_f32 v[114:115], v[104:105], v[112:113] op_sel_hi:[1,0]
    v_pk_mul_f32 v[116:117], v[106:107], v[112:113] op_sel_hi:[1,0]
    v_pk_mul_f32 v[118:119], v[108:109], v[112:113] op_sel_hi:[1,0]
    v_pk_mul_f32 v[120:121], v[110:111], v[112:113] op_sel_hi:[1,0]
    v_pk_fma_f32 v[104:105], v[104:105], v[112:113], v[114:115] op_sel:[1,1,0] op_sel_hi:[0,1,1] neg_lo:[0,1,0]
    v_pk_fma_f32 v[106:107], v[106:107], v[112:113], v[116:117] op_sel:[1,1,0] op_sel_hi:[0,1,1] neg_lo:[0,1,0]
    v_pk_fma_f32 v[108:109], v[108:109], v[112:113], v[118:119] op_sel:[1,1,0] op_sel_hi:[0,1,1] neg_lo:[0,1,0]
    v_pk_fma_f32 v[110:111], v[110:111], v[112:113], v[120:121] op_sel:[1,1,0] op_sel_hi:[0,1,1] neg_lo:[0,1,0]
    v_cndmask_b32 v128, v128, v122, s[96:97]
    v_cvt_pk_bf16_f32 v136, v104, -v105
    buffer_load_dwordx4 a[224:227], v19, s[16:19], s68 offen sc1
    v_cvt_pk_bf16_f32 v137, v106, -v107
    v_cvt_pk_bf16_f32 v138, v108, -v109
    v_cvt_pk_bf16_f32 v139, v110, -v111
    v_pk_mul_f32 v[114:115], v[104:105], v[112:113] op_sel_hi:[1,0]
    v_pk_mul_f32 v[116:117], v[106:107], v[112:113] op_sel_hi:[1,0]
    v_pk_mul_f32 v[118:119], v[108:109], v[112:113] op_sel_hi:[1,0]
    v_pk_mul_f32 v[120:121], v[110:111], v[112:113] op_sel_hi:[1,0]
    v_pk_fma_f32 v[104:105], v[104:105], v[112:113], v[114:115] op_sel:[1,1,0] op_sel_hi:[0,1,1] neg_lo:[0,1,0]
    v_pk_fma_f32 v[106:107], v[106:107], v[112:113], v[116:117] op_sel:[1,1,0] op_sel_hi:[0,1,1] neg_lo:[0,1,0]
    v_pk_fma_f32 v[108:109], v[108:109], v[112:113], v[118:119] op_sel:[1,1,0] op_sel_hi:[0,1,1] neg_lo:[0,1,0]
    v_pk_fma_f32 v[110:111], v[110:111], v[112:113], v[120:121] op_sel:[1,1,0] op_sel_hi:[0,1,1] neg_lo:[0,1,0]
    v_cvt_pk_bf16_f32 v144, v104, -v105
    v_cvt_pk_bf16_f32 v145, v106, -v107
    v_cvt_pk_bf16_f32 v146, v108, -v109
    v_cvt_pk_bf16_f32 v147, v110, -v111
    v_pk_mul_f32 v[114:115], v[104:105], v[112:113] op_sel_hi:[1,0]
    v_pk_mul_f32 v[116:117], v[106:107], v[112:113] op_sel_hi:[1,0]
    v_pk_mul_f32 v[118:119], v[108:109], v[112:113] op_sel_hi:[1,0]
    v_pk_mul_f32 v[120:121], v[110:111], v[112:113] op_sel_hi:[1,0]
    v_pk_fma_f32 v[104:105], v[104:105], v[112:113], v[114:115] op_sel:[1,1,0] op_sel_hi:[0,1,1] neg_lo:[0,1,0]
    v_pk_fma_f32 v[106:107], v[106:107], v[112:113], v[116:117] op_sel:[1,1,0] op_sel_hi:[0,1,1] neg_lo:[0,1,0]
    v_pk_fma_f32 v[108:109], v[108:109], v[112:113], v[118:119] op_sel:[1,1,0] op_sel_hi:[0,1,1] neg_lo:[0,1,0]
    v_pk_fma_f32 v[110:111], v[110:111], v[112:113], v[120:121] op_sel:[1,1,0] op_sel_hi:[0,1,1] neg_lo:[0,1,0]
    v_cvt_pk_bf16_f32 v152, v104, -v105
    v_cvt_pk_bf16_f32 v153, v106, -v107
    buffer_load_dwordx4 a[228:231], v20, s[16:19], s68 offen sc1
    v_cvt_pk_bf16_f32 v154, v108, -v109
    v_cvt_pk_bf16_f32 v155, v110, -v111
    v_pk_mul_f32 v[114:115], v[104:105], v[112:113] op_sel_hi:[1,0]
    v_pk_mul_f32 v[116:117], v[106:107], v[112:113] op_sel_hi:[1,0]
    v_pk_mul_f32 v[118:119], v[108:109], v[112:113] op_sel_hi:[1,0]
    v_pk_mul_f32 v[120:121], v[110:111], v[112:113] op_sel_hi:[1,0]
    v_pk_fma_f32 v[104:105], v[104:105], v[112:113], v[114:115] op_sel:[1,1,0] op_sel_hi:[0,1,1] neg_lo:[0,1,0]
    v_pk_fma_f32 v[106:107], v[106:107], v[112:113], v[116:117] op_sel:[1,1,0] op_sel_hi:[0,1,1] neg_lo:[0,1,0]
    v_pk_fma_f32 v[108:109], v[108:109], v[112:113], v[118:119] op_sel:[1,1,0] op_sel_hi:[0,1,1] neg_lo:[0,1,0]
    v_pk_fma_f32 v[110:111], v[110:111], v[112:113], v[120:121] op_sel:[1,1,0] op_sel_hi:[0,1,1] neg_lo:[0,1,0]
    v_cvt_pk_bf16_f32 v160, v104, -v105
    v_cvt_pk_bf16_f32 v161, v106, -v107
    v_cvt_pk_bf16_f32 v162, v108, -v109
    v_cvt_pk_bf16_f32 v163, v110, -v111
    v_pk_mul_f32 v[114:115], v[104:105], v[112:113] op_sel_hi:[1,0]
    v_pk_mul_f32 v[116:117], v[106:107], v[112:113] op_sel_hi:[1,0]
    v_pk_mul_f32 v[118:119], v[108:109], v[112:113] op_sel_hi:[1,0]
    v_pk_mul_f32 v[120:121], v[110:111], v[112:113] op_sel_hi:[1,0]
    v_pk_fma_f32 v[104:105], v[104:105], v[112:113], v[114:115] op_sel:[1,1,0] op_sel_hi:[0,1,1] neg_lo:[0,1,0]
    v_pk_fma_f32 v[106:107], v[106:107], v[112:113], v[116:117] op_sel:[1,1,0] op_sel_hi:[0,1,1] neg_lo:[0,1,0]
    v_pk_fma_f32 v[108:109], v[108:109], v[112:113], v[118:119] op_sel:[1,1,0] op_sel_hi:[0,1,1] neg_lo:[0,1,0]
    v_pk_fma_f32 v[110:111], v[110:111], v[112:113], v[120:121] op_sel:[1,1,0] op_sel_hi:[0,1,1] neg_lo:[0,1,0]
    v_cvt_pk_bf16_f32 v168, v104, -v105
    v_cvt_pk_bf16_f32 v169, v106, -v107
    v_cvt_pk_bf16_f32 v170, v108, -v109
    buffer_load_dwordx4 a[232:235], v19, s[16:19], s69 offen sc1
    v_cvt_pk_bf16_f32 v171, v110, -v111
    v_pk_mul_f32 v[114:115], v[104:105], v[112:113] op_sel_hi:[1,0]
    v_pk_mul_f32 v[116:117], v[106:107], v[112:113] op_sel_hi:[1,0]
    v_pk_mul_f32 v[118:119], v[108:109], v[112:113] op_sel_hi:[1,0]
    v_pk_mul_f32 v[120:121], v[110:111], v[112:113] op_sel_hi:[1,0]
    v_pk_fma_f32 v[104:105], v[104:105], v[112:113], v[114:115] op_sel:[1,1,0] op_sel_hi:[0,1,1] neg_lo:[0,1,0]
    v_pk_fma_f32 v[106:107], v[106:107], v[112:113], v[116:117] op_sel:[1,1,0] op_sel_hi:[0,1,1] neg_lo:[0,1,0]
    v_pk_fma_f32 v[108:109], v[108:109], v[112:113], v[118:119] op_sel:[1,1,0] op_sel_hi:[0,1,1] neg_lo:[0,1,0]
    v_pk_fma_f32 v[110:111], v[110:111], v[112:113], v[120:121] op_sel:[1,1,0] op_sel_hi:[0,1,1] neg_lo:[0,1,0]
    v_cvt_pk_bf16_f32 v176, v104, -v105
    v_cvt_pk_bf16_f32 v177, v106, -v107
    v_cvt_pk_bf16_f32 v178, v108, -v109
    v_cvt_pk_bf16_f32 v179, v110, -v111
    v_pk_mul_f32 v[114:115], v[104:105], v[112:113] op_sel_hi:[1,0]
    v_pk_mul_f32 v[116:117], v[106:107], v[112:113] op_sel_hi:[1,0]
    v_pk_mul_f32 v[118:119], v[108:109], v[112:113] op_sel_hi:[1,0]
    v_pk_mul_f32 v[120:121], v[110:111], v[112:113] op_sel_hi:[1,0]
    v_pk_fma_f32 v[104:105], v[104:105], v[112:113], v[114:115] op_sel:[1,1,0] op_sel_hi:[0,1,1] neg_lo:[0,1,0]
    v_pk_fma_f32 v[106:107], v[106:107], v[112:113], v[116:117] op_sel:[1,1,0] op_sel_hi:[0,1,1] neg_lo:[0,1,0]
    v_pk_fma_f32 v[108:109], v[108:109], v[112:113], v[118:119] op_sel:[1,1,0] op_sel_hi:[0,1,1] neg_lo:[0,1,0]
    v_pk_fma_f32 v[110:111], v[110:111], v[112:113], v[120:121] op_sel:[1,1,0] op_sel_hi:[0,1,1] neg_lo:[0,1,0]
    v_cvt_pk_bf16_f32 v184, v104, -v105
    v_cvt_pk_bf16_f32 v185, v106, -v107
    v_cvt_pk_bf16_f32 v186, v108, -v109
    v_cvt_pk_bf16_f32 v187, v110, -v111
    buffer_load_dwordx4 a[236:239], v20, s[16:19], s69 offen sc1
    v_and_b32 v40, 31, v1
    s_lshl_b32 s60, s41, 6
    s_add_u32 s60, s60, 32
    v_add_u32 v40, s60, v40
    v_lshrrev_b32 v43, 5, v1
    v_lshlrev_b32 v43, 1, v43
    s_lshl_b32 s60, s33, 6
    v_add_u32 v43, s60, v43
    v_cmp_eq_u32 s[96:97], 0, v43
    v_mul_u32_u24 v43, v43, v40
    v_and_b32 v43, 511, v43
    v_cvt_f32_u32 v42, v43
    v_mul_f32 v42, 0x3b000000, v42
    v_cvt_f32_u32 v41, v40
    v_and_b32 v43, 1, v40
    v_lshlrev_b32 v43, 15, v43
    v_xor_b32 v122, 0x3f80, v43
    v_mul_f32 v43, 0x3c800000, v41
    v_mul_f32 v41, 0x3b000000, v41
    v_cos_f32 v112, v43
    v_sin_f32 v113, v43
    v_cos_f32 v104, v42
    v_sin_f32 v105, v42
    v_add_f32 v42, v42, v41
    v_cos_f32 v106, v42
    v_sin_f32 v107, v42
    v_fmac_f32 v42, 0x40400000, v41
    v_cos_f32 v108, v42
    v_sin_f32 v109, v42
    v_add_f32 v42, v42, v41
    v_cos_f32 v110, v42
    v_sin_f32 v111, v42
    v_cvt_pk_bf16_f32 v132, v104, -v105
    v_cvt_pk_bf16_f32 v133, v106, -v107
    v_cvt_pk_bf16_f32 v134, v108, -v109
    v_cvt_pk_bf16_f32 v135, v110, -v111
    v_pk_mul_f32 v[114:115], v[104:105], v[112:113] op_sel_hi:[1,0]
    v_pk_mul_f32 v[116:117], v[106:107], v[112:113] op_sel_hi:[1,0]
    v_pk_mul_f32 v[118:119], v[108:109], v[112:113] op_sel_hi:[1,0]
    v_pk_mul_f32 v[120:121], v[110:111], v[112:113] op_sel_hi:[1,0]
    v_pk_fma_f32 v[104:105], v[104:105], v[112:113], v[114:115] op_sel:[1,1,0] op_sel_hi:[0,1,1] neg_lo:[0,1,0]
    v_pk_fma_f32 v[106:107], v[106:107], v[112:113], v[116:117] op_sel:[1,1,0] op_sel_hi:[0,1,1] neg_lo:[0,1,0]
    v_pk_fma_f32 v[108:109], v[108:109], v[112:113], v[118:119] op_sel:[1,1,0] op_sel_hi:[0,1,1] neg_lo:[0,1,0]
    v_pk_fma_f32 v[110:111], v[110:111], v[112:113], v[120:121] op_sel:[1,1,0] op_sel_hi:[0,1,1] neg_lo:[0,1,0]
    v_cndmask_b32 v132, v132, v122, s[96:97]
    v_cvt_pk_bf16_f32 v140, v104, -v105
    buffer_load_dwordx4 a[240:243], v19, s[16:19], s70 offen sc1
    v_cvt_pk_bf16_f32 v141, v106, -v107
    v_cvt_pk_bf16_f32 v142, v108, -v109
    v_cvt_pk_bf16_f32 v143, v110, -v111
    v_pk_mul_f32 v[114:115], v[104:105], v[112:113] op_sel_hi:[1,0]
    v_pk_mul_f32 v[116:117], v[106:107], v[112:113] op_sel_hi:[1,0]
    v_pk_mul_f32 v[118:119], v[108:109], v[112:113] op_sel_hi:[1,0]
    v_pk_mul_f32 v[120:121], v[110:111], v[112:113] op_sel_hi:[1,0]
    v_pk_fma_f32 v[104:105], v[104:105], v[112:113], v[114:115] op_sel:[1,1,0] op_sel_hi:[0,1,1] neg_lo:[0,1,0]
    v_pk_fma_f32 v[106:107], v[106:107], v[112:113], v[116:117] op_sel:[1,1,0] op_sel_hi:[0,1,1] neg_lo:[0,1,0]
    v_pk_fma_f32 v[108:109], v[108:109], v[112:113], v[118:119] op_sel:[1,1,0] op_sel_hi:[0,1,1] neg_lo:[0,1,0]
    v_pk_fma_f32 v[110:111], v[110:111], v[112:113], v[120:121] op_sel:[1,1,0] op_sel_hi:[0,1,1] neg_lo:[0,1,0]
    v_cvt_pk_bf16_f32 v148, v104, -v105
    v_cvt_pk_bf16_f32 v149, v106, -v107
    v_cvt_pk_bf16_f32 v150, v108, -v109
    v_cvt_pk_bf16_f32 v151, v110, -v111
    v_pk_mul_f32 v[114:115], v[104:105], v[112:113] op_sel_hi:[1,0]
    v_pk_mul_f32 v[116:117], v[106:107], v[112:113] op_sel_hi:[1,0]
    v_pk_mul_f32 v[118:119], v[108:109], v[112:113] op_sel_hi:[1,0]
    v_pk_mul_f32 v[120:121], v[110:111], v[112:113] op_sel_hi:[1,0]
    v_pk_fma_f32 v[104:105], v[104:105], v[112:113], v[114:115] op_sel:[1,1,0] op_sel_hi:[0,1,1] neg_lo:[0,1,0]
    v_pk_fma_f32 v[106:107], v[106:107], v[112:113], v[116:117] op_sel:[1,1,0] op_sel_hi:[0,1,1] neg_lo:[0,1,0]
    v_pk_fma_f32 v[108:109], v[108:109], v[112:113], v[118:119] op_sel:[1,1,0] op_sel_hi:[0,1,1] neg_lo:[0,1,0]
    v_pk_fma_f32 v[110:111], v[110:111], v[112:113], v[120:121] op_sel:[1,1,0] op_sel_hi:[0,1,1] neg_lo:[0,1,0]
    v_cvt_pk_bf16_f32 v156, v104, -v105
    v_cvt_pk_bf16_f32 v157, v106, -v107
    buffer_load_dwordx4 a[244:247], v20, s[16:19], s70 offen sc1
    v_cvt_pk_bf16_f32 v158, v108, -v109
    v_cvt_pk_bf16_f32 v159, v110, -v111
    v_pk_mul_f32 v[114:115], v[104:105], v[112:113] op_sel_hi:[1,0]
    v_pk_mul_f32 v[116:117], v[106:107], v[112:113] op_sel_hi:[1,0]
    v_pk_mul_f32 v[118:119], v[108:109], v[112:113] op_sel_hi:[1,0]
    v_pk_mul_f32 v[120:121], v[110:111], v[112:113] op_sel_hi:[1,0]
    v_pk_fma_f32 v[104:105], v[104:105], v[112:113], v[114:115] op_sel:[1,1,0] op_sel_hi:[0,1,1] neg_lo:[0,1,0]
    v_pk_fma_f32 v[106:107], v[106:107], v[112:113], v[116:117] op_sel:[1,1,0] op_sel_hi:[0,1,1] neg_lo:[0,1,0]
    v_pk_fma_f32 v[108:109], v[108:109], v[112:113], v[118:119] op_sel:[1,1,0] op_sel_hi:[0,1,1] neg_lo:[0,1,0]
    v_pk_fma_f32 v[110:111], v[110:111], v[112:113], v[120:121] op_sel:[1,1,0] op_sel_hi:[0,1,1] neg_lo:[0,1,0]
    v_cvt_pk_bf16_f32 v164, v104, -v105
    v_cvt_pk_bf16_f32 v165, v106, -v107
    v_cvt_pk_bf16_f32 v166, v108, -v109
    v_cvt_pk_bf16_f32 v167, v110, -v111
    v_pk_mul_f32 v[114:115], v[104:105], v[112:113] op_sel_hi:[1,0]
    v_pk_mul_f32 v[116:117], v[106:107], v[112:113] op_sel_hi:[1,0]
    v_pk_mul_f32 v[118:119], v[108:109], v[112:113] op_sel_hi:[1,0]
    v_pk_mul_f32 v[120:121], v[110:111], v[112:113] op_sel_hi:[1,0]
    v_pk_fma_f32 v[104:105], v[104:105], v[112:113], v[114:115] op_sel:[1,1,0] op_sel_hi:[0,1,1] neg_lo:[0,1,0]
    v_pk_fma_f32 v[106:107], v[106:107], v[112:113], v[116:117] op_sel:[1,1,0] op_sel_hi:[0,1,1] neg_lo:[0,1,0]
    v_pk_fma_f32 v[108:109], v[108:109], v[112:113], v[118:119] op_sel:[1,1,0] op_sel_hi:[0,1,1] neg_lo:[0,1,0]
    v_pk_fma_f32 v[110:111], v[110:111], v[112:113], v[120:121] op_sel:[1,1,0] op_sel_hi:[0,1,1] neg_lo:[0,1,0]
    v_cvt_pk_bf16_f32 v172, v104, -v105
    v_cvt_pk_bf16_f32 v173, v106, -v107
    v_cvt_pk_bf16_f32 v174, v108, -v109
    buffer_load_dwordx4 a[248:251], v19, s[16:19], s71 offen sc1
    v_cvt_pk_bf16_f32 v175, v110, -v111
    v_pk_mul_f32 v[114:115], v[104:105], v[112:113] op_sel_hi:[1,0]
    v_pk_mul_f32 v[116:117], v[106:107], v[112:113] op_sel_hi:[1,0]
    v_pk_mul_f32 v[118:119], v[108:109], v[112:113] op_sel_hi:[1,0]
    v_pk_mul_f32 v[120:121], v[110:111], v[112:113] op_sel_hi:[1,0]
    v_pk_fma_f32 v[104:105], v[104:105], v[112:113], v[114:115] op_sel:[1,1,0] op_sel_hi:[0,1,1] neg_lo:[0,1,0]
    v_pk_fma_f32 v[106:107], v[106:107], v[112:113], v[116:117] op_sel:[1,1,0] op_sel_hi:[0,1,1] neg_lo:[0,1,0]
    v_pk_fma_f32 v[108:109], v[108:109], v[112:113], v[118:119] op_sel:[1,1,0] op_sel_hi:[0,1,1] neg_lo:[0,1,0]
    v_pk_fma_f32 v[110:111], v[110:111], v[112:113], v[120:121] op_sel:[1,1,0] op_sel_hi:[0,1,1] neg_lo:[0,1,0]
    v_cvt_pk_bf16_f32 v180, v104, -v105
    v_cvt_pk_bf16_f32 v181, v106, -v107
    v_cvt_pk_bf16_f32 v182, v108, -v109
    v_cvt_pk_bf16_f32 v183, v110, -v111
    v_pk_mul_f32 v[114:115], v[104:105], v[112:113] op_sel_hi:[1,0]
    v_pk_mul_f32 v[116:117], v[106:107], v[112:113] op_sel_hi:[1,0]
    v_pk_mul_f32 v[118:119], v[108:109], v[112:113] op_sel_hi:[1,0]
    v_pk_mul_f32 v[120:121], v[110:111], v[112:113] op_sel_hi:[1,0]
    v_pk_fma_f32 v[104:105], v[104:105], v[112:113], v[114:115] op_sel:[1,1,0] op_sel_hi:[0,1,1] neg_lo:[0,1,0]
    v_pk_fma_f32 v[106:107], v[106:107], v[112:113], v[116:117] op_sel:[1,1,0] op_sel_hi:[0,1,1] neg_lo:[0,1,0]
    v_pk_fma_f32 v[108:109], v[108:109], v[112:113], v[118:119] op_sel:[1,1,0] op_sel_hi:[0,1,1] neg_lo:[0,1,0]
    v_pk_fma_f32 v[110:111], v[110:111], v[112:113], v[120:121] op_sel:[1,1,0] op_sel_hi:[0,1,1] neg_lo:[0,1,0]
    v_cvt_pk_bf16_f32 v188, v104, -v105
    v_cvt_pk_bf16_f32 v189, v106, -v107
    v_cvt_pk_bf16_f32 v190, v108, -v109
    v_cvt_pk_bf16_f32 v191, v110, -v111
    buffer_load_dwordx4 a[252:255], v20, s[16:19], s71 offen sc1
    s_waitcnt lgkmcnt(0)
    ds_read_b64_tr_b16 a[160:161], v13 offset:0
    ds_read_b64_tr_b16 a[162:163], v13 offset:1024
    ds_read_b64_tr_b16 a[164:165], v14 offset:0
    ds_read_b64_tr_b16 a[166:167], v14 offset:1024
    ds_read_b64_tr_b16 a[168:169], v13 offset:2048
    ds_read_b64_tr_b16 a[170:171], v13 offset:3072
    ds_read_b64_tr_b16 a[172:173], v14 offset:2048
    ds_read_b64_tr_b16 a[174:175], v14 offset:3072
    s_lshr_b32 s50, s40, 3
    s_lshl_b32 s50, s50, 3
    s_lshl_b32 s51, s33, 1
    s_add_u32 s50, s50, s51
    s_lshl_b32 s50, s50, 9
    s_add_u32 s58, s50, 163840
    s_lshl_b32 s50, s40, 16
    s_add_u32 s50, s50, s56
    s_add_u32 s50, s50, 3145728
    s_waitcnt vmcnt(14)
    s_waitcnt lgkmcnt(4)
    v_mfma_f32_32x32x16_bf16 v[64:79], a[192:195], a[160:163], 0
    ds_read_b64_tr_b16 a[176:177], v13 offset:4096
    ds_read_b64_tr_b16 a[178:179], v13 offset:5120
    ds_read_b64_tr_b16 a[180:181], v14 offset:4096
    v_mfma_f32_32x32x16_bf16 v[80:95], a[192:195], a[164:167], 0
    buffer_load_dwordx4 a[192:195], v19, s[16:19], s72 offen sc1
    v_mfma_f32_32x32x16_bf16 v[96:111], a[196:199], a[160:163], 0
    ds_read_b64_tr_b16 a[182:183], v14 offset:5120
    v_lshrrev_b32 v58, 3, v1
    v_and_b32 v59, 1, v58
    v_bfe_u32 v60, v58, 1, 1
    v_mfma_f32_32x32x16_bf16 v[112:127], a[196:199], a[164:167], 0
    buffer_load_dwordx4 a[196:199], v20, s[16:19], s72 offen sc1
    s_waitcnt vmcnt(14)
    s_waitcnt lgkmcnt(4)
    v_mfma_f32_32x32x16_bf16 v[64:79], a[200:203], a[168:171], v[64:79]
    ds_read_b64_tr_b16 a[160:161], v13 offset:6144
    ds_read_b64_tr_b16 a[162:163], v13 offset:7168
    ds_read_b64_tr_b16 a[164:165], v14 offset:6144
    v_mfma_f32_32x32x16_bf16 v[80:95], a[200:203], a[172:175], v[80:95]
    buffer_load_dwordx4 a[200:203], v19, s[16:19], s73 offen sc1
    v_mfma_f32_32x32x16_bf16 v[96:111], a[204:207], a[168:171], v[96:111]
    ds_read_b64_tr_b16 a[166:167], v14 offset:7168
    v_lshrrev_b32 v61, 2, v58
    v_lshl_add_u32 v59, v61, 1, v59
    v_lshl_add_u32 v61, v60, 2, v59
    v_mfma_f32_32x32x16_bf16 v[112:127], a[204:207], a[172:175], v[112:127]
    buffer_load_dwordx4 a[204:207], v20, s[16:19], s73 offen sc1
    s_waitcnt vmcnt(14)
    s_waitcnt lgkmcnt(4)
    v_mfma_f32_32x32x16_bf16 v[64:79], a[208:211], a[176:179], v[64:79]
    ds_read_b64_tr_b16 a[168:169], v13 offset:8192
    ds_read_b64_tr_b16 a[170:171], v13 offset:9216
    ds_read_b64_tr_b16 a[172:173], v14 offset:8192
    v_mfma_f32_32x32x16_bf16 v[80:95], a[208:211], a[180:183], v[80:95]
    buffer_load_dwordx4 a[208:211], v19, s[16:19], s74 offen sc1
    v_mfma_f32_32x32x16_bf16 v[96:111], a[212:215], a[176:179], v[96:111]
    ds_read_b64_tr_b16 a[174:175], v14 offset:9216
    v_and_b32 v62, 7, v1
    v_lshlrev_b32 v4, 4, v62
    v_lshl_add_u32 v4, v61, 16, v4
    v_mfma_f32_32x32x16_bf16 v[112:127], a[212:215], a[180:183], v[112:127]
    buffer_load_dwordx4 a[212:215], v20, s[16:19], s74 offen sc1
    s_waitcnt vmcnt(14)
    s_waitcnt lgkmcnt(4)
    v_mfma_f32_32x32x16_bf16 v[64:79], a[216:219], a[160:163], v[64:79]
    ds_read_b64_tr_b16 a[176:177], v13 offset:10240
    ds_read_b64_tr_b16 a[178:179], v13 offset:11264
    ds_read_b64_tr_b16 a[180:181], v14 offset:10240
    v_mfma_f32_32x32x16_bf16 v[80:95], a[216:219], a[164:167], v[80:95]
    buffer_load_dwordx4 a[216:219], v19, s[16:19], s75 offen sc1
    v_mfma_f32_32x32x16_bf16 v[96:111], a[220:223], a[160:163], v[96:111]
    ds_read_b64_tr_b16 a[182:183], v14 offset:11264
    v_lshlrev_b32 v5, 8, v59
    v_lshl_add_u32 v5, v60, 7, v5
    v_and_b32 v59, 3, v1
    v_mfma_f32_32x32x16_bf16 v[112:127], a[220:223], a[164:167], v[112:127]
    buffer_load_dwordx4 a[220:223], v20, s[16:19], s75 offen sc1
    s_waitcnt vmcnt(14)
    s_waitcnt lgkmcnt(4)
    v_mfma_f32_32x32x16_bf16 v[64:79], a[224:227], a[168:171], v[64:79]
    ds_read_b64_tr_b16 a[160:161], v13 offset:12288
    ds_read_b64_tr_b16 a[162:163], v13 offset:13312
    ds_read_b64_tr_b16 a[164:165], v14 offset:12288
    v_mfma_f32_32x32x16_bf16 v[80:95], a[224:227], a[172:175], v[80:95]
    buffer_load_dwordx4 a[224:227], v19, s[16:19], s76 offen sc1
    v_mfma_f32_32x32x16_bf16 v[96:111], a[228:231], a[168:171], v[96:111]
    ds_read_b64_tr_b16 a[166:167], v14 offset:13312
    v_lshl_add_u32 v5, v59, 5, v5
    v_bfe_u32 v59, v1, 2, 1
    v_mul_u32_u24 v59, 4112, v59
    v_mfma_f32_32x32x16_bf16 v[112:127], a[228:231], a[172:175], v[112:127]
    buffer_load_dwordx4 a[228:231], v20, s[16:19], s76 offen sc1
    s_waitcnt vmcnt(14)
    s_waitcnt lgkmcnt(4)
    v_mfma_f32_32x32x16_bf16 v[64:79], a[232:235], a[176:179], v[64:79]
    buffer_load_dword v7, v26, s[16:19], s58 offen sc1
    v_mfma_f32_32x32x16_bf16 v[80:95], a[232:235], a[180:183], v[80:95]
    buffer_load_dwordx4 a[232:235], v19, s[16:19], s77 offen sc1
    v_mfma_f32_32x32x16_bf16 v[96:111], a[236:239], a[176:179], v[96:111]
    ds_read_b64_tr_b16 a[168:169], v13 offset:14336
    ds_read_b64_tr_b16 a[170:171], v13 offset:15360
    ds_read_b64_tr_b16 a[172:173], v14 offset:14336
    v_mfma_f32_32x32x16_bf16 v[112:127], a[236:239], a[180:183], v[112:127]
    buffer_load_dwordx4 a[236:239], v20, s[16:19], s77 offen sc1
    s_waitcnt vmcnt(15)
    s_waitcnt lgkmcnt(3)
    v_mfma_f32_32x32x16_bf16 v[64:79], a[240:243], a[160:163], v[64:79]
    ds_read_b64_tr_b16 a[174:175], v14 offset:15360
    ds_read_b64_tr_b16 a[176:177], v9 offset:0
    ds_read_b64_tr_b16 a[178:179], v9 offset:1024
    v_mfma_f32_32x32x16_bf16 v[80:95], a[240:243], a[164:167], v[80:95]
    buffer_load_dwordx4 a[240:243], v19, s[16:19], s78 offen sc1
    v_mfma_f32_32x32x16_bf16 v[96:111], a[244:247], a[160:163], v[96:111]
    ds_read_b64_tr_b16 a[180:181], v10 offset:0
    ds_read_b64_tr_b16 a[182:183], v10 offset:1024
    v_add_u32 v5, v5, v59
    v_mfma_f32_32x32x16_bf16 v[112:127], a[244:247], a[164:167], v[112:127]
    buffer_load_dwordx4 a[244:247], v20, s[16:19], s78 offen sc1
    s_waitcnt vmcnt(15)
    s_waitcnt lgkmcnt(4)
    v_mfma_f32_32x32x16_bf16 v[64:79], a[248:251], a[168:171], v[64:79]
    ds_read_b64_tr_b16 a[160:161], v9 offset:2048
    ds_read_b64_tr_b16 a[162:163], v9 offset:3072
    ds_read_b64_tr_b16 a[164:165], v10 offset:2048
    v_mfma_f32_32x32x16_bf16 v[80:95], a[248:251], a[172:175], v[80:95]
    ds_read_b64_tr_b16 a[166:167], v10 offset:3072
    s_lshl_b32 s60, s33, 10
    v_add_u32 v5, s60, v5
    s_lshl_b32 s59, s33, 19
    v_mfma_f32_32x32x16_bf16 v[96:111], a[252:255], a[168:171], v[96:111]
    buffer_load_dwordx4 a[248:251], v19, s[16:19], s79 offen sc1
    v_mfma_f32_32x32x16_bf16 v[112:127], a[252:255], a[172:175], v[112:127]
    buffer_load_dwordx4 a[252:255], v20, s[16:19], s79 offen sc1
    s_waitcnt vmcnt(15)
    s_waitcnt lgkmcnt(4)
    v_mfma_f32_32x32x16_bf16 v[64:79], a[192:195], a[176:179], v[64:79]
    ds_read_b64_tr_b16 a[168:169], v9 offset:4096
    ds_read_b64_tr_b16 a[170:171], v9 offset:5120
    ds_read_b64_tr_b16 a[172:173], v10 offset:4096
    v_mfma_f32_32x32x16_bf16 v[80:95], a[192:195], a[180:183], v[80:95]
    ds_read_b64_tr_b16 a[174:175], v10 offset:5120
    s_lshl_b32 s60, s40, 11
    s_add_u32 s59, s59, s60
    s_add_u32 s59, s59, s48
    v_mfma_f32_32x32x16_bf16 v[96:111], a[196:199], a[176:179], v[96:111]
    v_lshrrev_b32 v58, 5, v1
    v_bfe_u32 v59, v1, 2, 2
    v_lshl_add_u32 v58, v58, 3, v59
    v_lshlrev_b32 v58, 6, v58
    v_mfma_f32_32x32x16_bf16 v[112:127], a[196:199], a[180:183], v[112:127]
    v_and_b32 v59, 3, v1
    v_lshl_add_u32 v58, v59, 3, v58
    v_and_b32 v59, 16, v1
    v_lshl_add_u32 v58, v59, 1, v58
    s_waitcnt vmcnt(6)
    v_cmp_ne_u32 vcc, s32, v7
    s_nop 1
    s_cbranch_vccnz L_again_23
L_back_24:
    s_waitcnt lgkmcnt(4)
    s_add_u32 m0, s56, 98304
    v_mfma_f32_32x32x16_bf16 v[64:79], a[200:203], a[160:163], v[64:79]
    s_add_u32 s51, s50, 0
    buffer_load_dwordx4 v26, s[16:19], s51 offen sc1 lds
    s_add_u32 m0, s56, 99328
    s_add_u32 s51, s50, 1024
    buffer_load_dwordx4 v26, s[16:19], s51 offen sc1 lds
    s_add_u32 m0, s56, 100352
    s_add_u32 s51, s50, 2048
    buffer_load_dwordx4 v26, s[16:19], s51 offen sc1 lds
    s_add_u32 m0, s56, 101376
    s_add_u32 s51, s50, 3072
    buffer_load_dwordx4 v26, s[16:19], s51 offen sc1 lds
    v_mfma_f32_32x32x16_bf16 v[80:95], a[200:203], a[164:167], v[80:95]
    ds_read_b64_tr_b16 a[176:177], v9 offset:6144
    ds_read_b64_tr_b16 a[178:179], v9 offset:7168
    ds_read_b64_tr_b16 a[180:181], v10 offset:6144
    v_mfma_f32_32x32x16_bf16 v[96:111], a[204:207], a[160:163], v[96:111]
    ds_read_b64_tr_b16 a[182:183], v10 offset:7168
    s_add_u32 s60, s56, 98304
    v_add_u32 v15, s60, v58
    v_and_b32 v32, 1, v1
    v_mfma_f32_32x32x16_bf16 v[112:127], a[204:207], a[164:167], v[112:127]
    s_mov_b32 s60, 0x80008000
    v_mul_lo_u32 v35, v32, s60
    v_and_b32 v32, 31, v1
    v_cvt_f32_u32 v32, v32
    s_waitcnt lgkmcnt(4)
    v_mfma_f32_32x32x16_bf16 v[64:79], a[208:211], a[168:171], v[64:79]
    v_mul_f32 v33, 0x3d000000, v32
    v_lshrrev_b32 v32, 5, v1
    v_lshlrev_b32 v32, 2, v32
    v_cvt_f32_u32 v32, v32
    v_mfma_f32_32x32x16_bf16 v[80:95], a[208:211], a[172:175], v[80:95]
    v_mul_f32 v34, v32, v33
    v_cos_f32 v36, v34
    v_mfma_f32_32x32x16_bf16 v[96:111], a[212:215], a[168:171], v[96:111]
    v_sin_f32 v37, v34
    v_add_f32 v34, v34, v33
    v_cos_f32 v38, v34
    v_sin_f32 v39, v34
    v_add_f32 v34, v34, v33
    v_cvt_pk_bf16_f32 v192, v36, -v37
    v_cvt_pk_bf16_f32 v208, v37, v36
    v_xor_b32 v200, v192, v35
    v_xor_b32 v216, v208, v35
    v_cos_f32 v36, v34
    v_sin_f32 v37, v34
    v_add_f32 v34, v34, v33
    v_cvt_pk_bf16_f32 v193, v38, -v39
    v_cvt_pk_bf16_f32 v209, v39, v38
    v_xor_b32 v201, v193, v35
    v_xor_b32 v217, v209, v35
    v_cos_f32 v38, v34
    v_sin_f32 v39, v34
    v_fmac_f32 v34, 0x40a00000, v33
    v_cvt_pk_bf16_f32 v194, v36, -v37
    v_cvt_pk_bf16_f32 v210, v37, v36
    v_xor_b32 v202, v194, v35
    v_xor_b32 v218, v210, v35
    v_cos_f32 v36, v34
    v_sin_f32 v37, v34
    v_add_f32 v34, v34, v33
    v_cvt_pk_bf16_f32 v195, v38, -v39
    v_cvt_pk_bf16_f32 v211, v39, v38
    v_xor_b32 v203, v195, v35
    v_xor_b32 v219, v211, v35
    v_cos_f32 v38, v34
    v_sin_f32 v39, v34
    v_add_f32 v34, v34, v33
    v_cvt_pk_bf16_f32 v196, v36, -v37
    v_cvt_pk_bf16_f32 v212, v37, v36
    v_xor_b32 v204, v196, v35
    v_xor_b32 v220, v212, v35
    v_cos_f32 v36, v34
    v_sin_f32 v37, v34
    v_add_f32 v34, v34, v33
    v_cvt_pk_bf16_f32 v197, v38, -v39
    v_cvt_pk_bf16_f32 v213, v39, v38
    v_xor_b32 v205, v197, v35
    v_xor_b32 v221, v213, v35
    v_cos_f32 v38, v34
    v_sin_f32 v39, v34
    v_cvt_pk_bf16_f32 v198, v36, -v37
    v_cvt_pk_bf16_f32 v214, v37, v36
    v_xor_b32 v206, v198, v35
    v_xor_b32 v222, v214, v35
    v_cvt_pk_bf16_f32 v199, v38, -v39
    v_cvt_pk_bf16_f32 v215, v39, v38
    v_xor_b32 v207, v199, v35
    v_xor_b32 v223, v215, v35
    v_mfma_f32_32x32x16_bf16 v[112:127], a[212:215], a[172:175], v[112:127]
    buffer_load_dwordx4 a[192:195], v19, s[16:19], s80 offen sc1
    s_waitcnt lgkmcnt(0)
    v_mfma_f32_32x32x16_bf16 v[64:79], a[216:219], a[176:179], v[64:79]
    buffer_load_dwordx4 a[196:199], v20, s[16:19], s80 offen sc1
    v_mfma_f32_32x32x16_bf16 v[80:95], a[216:219], a[180:183], v[80:95]
    s_waitcnt vmcnt(2)
    ds_read_b64_tr_b16 a[128:129], v15 offset:0
    ds_read_b64_tr_b16 a[130:131], v15 offset:256
    ds_read_b64_tr_b16 a[132:133], v15 offset:1024
    v_mfma_f32_32x32x16_bf16 v[96:111], a[220:223], a[176:179], v[96:111]
    buffer_load_dwordx4 a[200:203], v19, s[16:19], s81 offen sc1
    v_mfma_f32_32x32x16_bf16 v[112:127], a[220:223], a[180:183], v[112:127]
    buffer_load_dwordx4 a[204:207], v20, s[16:19], s81 offen sc1
    v_mfma_f32_32x32x16_bf16 v[64:79], a[224:227], a[0:3], v[64:79]
    ds_read_b64_tr_b16 a[134:135], v15 offset:1280
    ds_read_b64_tr_b16 a[136:137], v15 offset:2048
    ds_read_b64_tr_b16 a[138:139], v15 offset:2304
    v_mfma_f32_32x32x16_bf16 v[80:95], a[224:227], a[4:7], v[80:95]
    ds_read_b64_tr_b16 a[140:141], v15 offset:3072
    ds_read_b64_tr_b16 a[142:143], v15 offset:3328
    s_add_u32 m0, s56, 102400
    v_mfma_f32_32x32x16_bf16 v[96:111], a[228:231], a[0:3], v[96:111]
    s_add_u32 s51, s50, 4096
    buffer_load_dwordx4 v26, s[16:19], s51 offen sc1 lds
    s_add_u32 m0, s56, 103424
    v_mfma_f32_32x32x16_bf16 v[112:127], a[228:231], a[4:7], v[112:127]
    s_add_u32 s51, s50, 5120
    buffer_load_dwordx4 v26, s[16:19], s51 offen sc1 lds
    s_waitcnt lgkmcnt(6)
    s_add_u32 m0, s56, 104448
    v_mfma_f32_32x32x16_bf16 v[224:239], a[128:131], v[192:195], 0
    s_add_u32 s51, s50, 6144
    buffer_load_dwordx4 v26, s[16:19], s51 offen sc1 lds
    s_add_u32 m0, s56, 105472
    v_mfma_f32_32x32x16_bf16 v[240:255], a[128:131], v[208:211], 0
    s_add_u32 s51, s50, 7168
    buffer_load_dwordx4 v26, s[16:19], s51 offen sc1 lds
    s_waitcnt lgkmcnt(4)
    v_mfma_f32_32x32x16_bf16 v[224:239], a[132:135], v[196:199], v[224:239]
    buffer_load_dwordx4 a[208:211], v19, s[16:19], s82 offen sc1
    v_mfma_f32_32x32x16_bf16 v[240:255], a[132:135], v[212:215], v[240:255]
    buffer_load_dwordx4 a[212:215], v20, s[16:19], s82 offen sc1
    s_waitcnt lgkmcnt(2)
    v_mfma_f32_32x32x16_bf16 v[224:239], a[136:139], v[200:203], v[224:239]
    buffer_load_dwordx4 a[216:219], v19, s[16:19], s83 offen sc1
    v_mfma_f32_32x32x16_bf16 v[240:255], a[136:139], v[216:219], v[240:255]
    buffer_load_dwordx4 a[220:223], v20, s[16:19], s83 offen sc1
    s_waitcnt lgkmcnt(0)
    s_add_u32 m0, s62, 49152
    v_mfma_f32_32x32x16_bf16 v[224:239], a[140:143], v[204:207], v[224:239]
    s_lshl4_add_u32 s55, s86, s48
    buffer_load_dwordx4 v2, s[12:15], s55 offen lds
    v_mfma_f32_32x32x16_bf16 v[240:255], a[140:143], v[220:223], v[240:255]
    buffer_load_dwordx4 v3, s[12:15], s55 offen offset:1024 lds
    s_add_u32 m0, s62, 57344
    v_mfma_f32_32x32x16_bf16 v[64:79], a[232:235], a[8:11], v[64:79]
    s_lshl4_add_u32 s55, s87, s48
    buffer_load_dwordx4 v2, s[12:15], s55 offen lds
    v_mfma_f32_32x32x16_bf16 v[80:95], a[232:235], a[12:15], v[80:95]
    buffer_load_dwordx4 v3, s[12:15], s55 offen offset:1024 lds
    v_mfma_f32_32x32x16_bf16 v[96:111], a[236:239], a[8:11], v[96:111]
    s_nop 3
    v_cvt_pk_bf16_f32 v32, v224, v240
    v_cvt_pk_bf16_f32 v33, v226, v242
    v_cvt_pk_bf16_f32 v34, v228, v244
    v_cvt_pk_bf16_f32 v35, v230, v246
    v_mfma_f32_32x32x16_bf16 v[112:127], a[236:239], a[12:15], v[112:127]
    v_cvt_pk_bf16_f32 v36, v225, v241
    v_cvt_pk_bf16_f32 v37, v227, v243
    v_cvt_pk_bf16_f32 v38, v229, v245
    v_cvt_pk_bf16_f32 v39, v231, v247
    v_mfma_f32_32x32x16_bf16 v[64:79], a[240:243], a[16:19], v[64:79]
    v_cvt_pk_bf16_f32 v40, v232, v248
    v_cvt_pk_bf16_f32 v41, v234, v250
    v_cvt_pk_bf16_f32 v42, v236, v252
    v_cvt_pk_bf16_f32 v43, v238, v254
    v_mfma_f32_32x32x16_bf16 v[80:95], a[240:243], a[20:23], v[80:95]
    v_cvt_pk_bf16_f32 v44, v233, v249
    v_cvt_pk_bf16_f32 v45, v235, v251
    v_cvt_pk_bf16_f32 v46, v237, v253
    v_cvt_pk_bf16_f32 v47, v239, v255
    s_add_u32 m0, s62, 65536
    v_mfma_f32_32x32x16_bf16 v[96:111], a[244:247], a[16:19], v[96:111]
    s_lshl4_add_u32 s55, s88, s48
    buffer_load_dwordx4 v2, s[12:15], s55 offen lds
    v_mfma_f32_32x32x16_bf16 v[112:127], a[244:247], a[20:23], v[112:127]
    buffer_load_dwordx4 v3, s[12:15], s55 offen offset:1024 lds
    s_add_u32 m0, s62, 73728
    v_mfma_f32_32x32x16_bf16 v[64:79], v[32:35], v[128:131], v[64:79]
    s_lshl4_add_u32 s55, s89, s48
    buffer_load_dwordx4 v2, s[12:15], s55 offen lds
    v_mfma_f32_32x32x16_bf16 v[80:95], v[32:35], v[132:135], v[80:95]
    buffer_load_dwordx4 v3, s[12:15], s55 offen offset:1024 lds
    s_add_u32 m0, s62, 81920
    v_mfma_f32_32x32x16_bf16 v[96:111], v[36:39], v[128:131], v[96:111]
    s_lshl4_add_u32 s55, s90, s48
    buffer_load_dwordx4 v2, s[12:15], s55 offen lds
    v_mfma_f32_32x32x16_bf16 v[112:127], v[36:39], v[132:135], v[112:127]
    buffer_load_dwordx4 v3, s[12:15], s55 offen offset:1024 lds
    s_add_u32 m0, s62, 90112
    v_mfma_f32_32x32x16_bf16 v[64:79], v[40:43], v[136:139], v[64:79]
    s_lshl4_add_u32 s55, s91, s48
    buffer_load_dwordx4 v2, s[12:15], s55 offen lds
    v_mfma_f32_32x32x16_bf16 v[80:95], v[40:43], v[140:143], v[80:95]
    buffer_load_dwordx4 v3, s[12:15], s55 offen offset:1024 lds
    v_mfma_f32_32x32x16_bf16 v[96:111], v[44:47], v[136:139], v[96:111]
    s_waitcnt vmcnt(16)
    ds_read_b64_tr_b16 a[144:145], v15 offset:4096
    ds_read_b64_tr_b16 a[146:147], v15 offset:4352
    ds_read_b64_tr_b16 a[148:149], v15 offset:5120
    v_mfma_f32_32x32x16_bf16 v[112:127], v[44:47], v[140:143], v[112:127]
    buffer_load_dwordx4 a[224:227], v19, s[16:19], s84 offen sc1
    v_mfma_f32_32x32x16_bf16 v[64:79], a[248:251], a[24:27], v[64:79]
    buffer_load_dwordx4 a[228:231], v20, s[16:19], s84 offen sc1
    v_mfma_f32_32x32x16_bf16 v[80:95], a[248:251], a[28:31], v[80:95]
    ds_read_b64_tr_b16 a[150:151], v15 offset:5376
    ds_read_b64_tr_b16 a[152:153], v15 offset:6144
    ds_read_b64_tr_b16 a[154:155], v15 offset:6400
    v_mfma_f32_32x32x16_bf16 v[96:111], a[252:255], a[24:27], v[96:111]
    ds_read_b64_tr_b16 a[156:157], v15 offset:7168
    ds_read_b64_tr_b16 a[158:159], v15 offset:7424
    s_add_u32 m0, s56, 106496
    v_mfma_f32_32x32x16_bf16 v[112:127], a[252:255], a[28:31], v[112:127]
    s_add_u32 s51, s50, 8192
    buffer_load_dwordx4 v26, s[16:19], s51 offen sc1 lds
    s_waitcnt lgkmcnt(6)
    s_add_u32 m0, s56, 107520
    v_mfma_f32_32x32x16_bf16 v[224:239], a[144:147], v[192:195], 0
    s_add_u32 s51, s50, 9216
    buffer_load_dwordx4 v26, s[16:19], s51 offen sc1 lds
    s_add_u32 m0, s56, 108544
    v_mfma_f32_32x32x16_bf16 v[240:255], a[144:147], v[208:211], 0
    s_add_u32 s51, s50, 10240
    buffer_load_dwordx4 v26, s[16:19], s51 offen sc1 lds
    s_waitcnt lgkmcnt(4)
    s_add_u32 m0, s56, 109568
    v_mfma_f32_32x32x16_bf16 v[224:239], a[148:151], v[196:199], v[224:239]
    s_add_u32 s51, s50, 11264
    buffer_load_dwordx4 v26, s[16:19], s51 offen sc1 lds
    v_mfma_f32_32x32x16_bf16 v[240:255], a[148:151], v[212:215], v[240:255]
    buffer_load_dwordx4 a[232:235], v19, s[16:19], s85 offen sc1
    s_waitcnt lgkmcnt(2)
    v_mfma_f32_32x32x16_bf16 v[224:239], a[152:155], v[200:203], v[224:239]
    buffer_load_dwordx4 a[236:239], v20, s[16:19], s85 offen sc1
    v_mfma_f32_32x32x16_bf16 v[240:255], a[152:155], v[216:219], v[240:255]
    buffer_load_dwordx4 a[240:243], v19, s[16:19], s86 offen sc1
    s_waitcnt lgkmcnt(0)
    v_mfma_f32_32x32x16_bf16 v[224:239], a[156:159], v[204:207], v[224:239]
    buffer_load_dwordx4 a[244:247], v20, s[16:19], s86 offen sc1
    v_mfma_f32_32x32x16_bf16 v[240:255], a[156:159], v[220:223], v[240:255]
    buffer_load_dwordx4 a[248:251], v19, s[16:19], s87 offen sc1
    v_mfma_f32_32x32x16_bf16 v[64:79], a[192:195], a[32:35], v[64:79]
    buffer_load_dwordx4 a[252:255], v20, s[16:19], s87 offen sc1
    s_add_u32 m0, s56, 110592
    v_mfma_f32_32x32x16_bf16 v[80:95], a[192:195], a[36:39], v[80:95]
    s_add_u32 s51, s50, 12288
    buffer_load_dwordx4 v26, s[16:19], s51 offen sc1 lds
    v_mfma_f32_32x32x16_bf16 v[96:111], a[196:199], a[32:35], v[96:111]
    s_nop 3
    v_cvt_pk_bf16_f32 v32, v224, v240
    v_cvt_pk_bf16_f32 v33, v226, v242
    v_cvt_pk_bf16_f32 v34, v228, v244
    v_cvt_pk_bf16_f32 v35, v230, v246
    v_mfma_f32_32x32x16_bf16 v[112:127], a[196:199], a[36:39], v[112:127]
    v_cvt_pk_bf16_f32 v36, v225, v241
    v_cvt_pk_bf16_f32 v37, v227, v243
    v_cvt_pk_bf16_f32 v38, v229, v245
    v_cvt_pk_bf16_f32 v39, v231, v247
    v_mfma_f32_32x32x16_bf16 v[64:79], a[200:203], a[40:43], v[64:79]
    v_cvt_pk_bf16_f32 v40, v232, v248
    v_cvt_pk_bf16_f32 v41, v234, v250
    v_cvt_pk_bf16_f32 v42, v236, v252
    v_cvt_pk_bf16_f32 v43, v238, v254
    v_mfma_f32_32x32x16_bf16 v[80:95], a[200:203], a[44:47], v[80:95]
    v_cvt_pk_bf16_f32 v44, v233, v249
    v_cvt_pk_bf16_f32 v45, v235, v251
    v_cvt_pk_bf16_f32 v46, v237, v253
    v_cvt_pk_bf16_f32 v47, v239, v255
    s_add_u32 m0, s56, 111616
    v_mfma_f32_32x32x16_bf16 v[96:111], a[204:207], a[40:43], v[96:111]
    s_add_u32 s51, s50, 13312
    buffer_load_dwordx4 v26, s[16:19], s51 offen sc1 lds
    s_add_u32 m0, s56, 112640
    v_mfma_f32_32x32x16_bf16 v[112:127], a[204:207], a[44:47], v[112:127]
    s_add_u32 s51, s50, 14336
    buffer_load_dwordx4 v26, s[16:19], s51 offen sc1 lds
    s_add_u32 m0, s56, 113664
    v_mfma_f32_32x32x16_bf16 v[64:79], v[32:35], v[144:147], v[64:79]
    s_add_u32 s51, s50, 15360
    buffer_load_dwordx4 v26, s[16:19], s51 offen sc1 lds
    v_mfma_f32_32x32x16_bf16 v[80:95], v[32:35], v[148:151], v[80:95]
    buffer_load_dwordx4 a[192:195], v19, s[16:19], s88 offen sc1
    v_mfma_f32_32x32x16_bf16 v[96:111], v[36:39], v[144:147], v[96:111]
    buffer_load_dwordx4 a[196:199], v20, s[16:19], s88 offen sc1
    v_mfma_f32_32x32x16_bf16 v[112:127], v[36:39], v[148:151], v[112:127]
    s_waitcnt vmcnt(12)
    ds_read_b64_tr_b16 a[128:129], v15 offset:8192
    ds_read_b64_tr_b16 a[130:131], v15 offset:8448
    ds_read_b64_tr_b16 a[132:133], v15 offset:9216
    v_mfma_f32_32x32x16_bf16 v[64:79], v[40:43], v[152:155], v[64:79]
    ds_read_b64_tr_b16 a[134:135], v15 offset:9472
    ds_read_b64_tr_b16 a[136:137], v15 offset:10240
    ds_read_b64_tr_b16 a[138:139], v15 offset:10496
    v_mfma_f32_32x32x16_bf16 v[80:95], v[40:43], v[156:159], v[80:95]
    ds_read_b64_tr_b16 a[140:141], v15 offset:11264
    ds_read_b64_tr_b16 a[142:143], v15 offset:11520
    ds_read_b64_tr_b16 a[80:81], v11 offset:0
    v_mfma_f32_32x32x16_bf16 v[96:111], v[44:47], v[152:155], v[96:111]
    ds_read_b64_tr_b16 a[82:83], v11 offset:1024
    ds_read_b64_tr_b16 a[84:85], v12 offset:0
    ds_read_b64_tr_b16 a[86:87], v12 offset:1024
    v_mfma_f32_32x32x16_bf16 v[112:127], v[44:47], v[156:159], v[112:127]
    ds_read_b64_tr_b16 a[88:89], v11 offset:8192
    ds_read_b64_tr_b16 a[90:91], v11 offset:9216
    ds_read_b64_tr_b16 a[92:93], v12 offset:8192
    v_mfma_f32_32x32x16_bf16 v[64:79], a[208:211], a[48:51], v[64:79]
    ds_read_b64_tr_b16 a[94:95], v12 offset:9216
    ds_read_b64_tr_b16 a[96:97], v11 offset:16384
    ds_read_b64_tr_b16 a[98:99], v11 offset:17408
    v_mfma_f32_32x32x16_bf16 v[80:95], a[208:211], a[52:55], v[80:95]
    ds_read_b64_tr_b16 a[100:101], v12 offset:16384
    ds_read_b64_tr_b16 a[102:103], v12 offset:17408
    ds_read_b64_tr_b16 a[104:105], v11 offset:24576
    v_mfma_f32_32x32x16_bf16 v[96:111], a[212:215], a[48:51], v[96:111]
    ds_read_b64_tr_b16 a[106:107], v11 offset:25600
    ds_read_b64_tr_b16 a[108:109], v12 offset:24576
    ds_read_b64_tr_b16 a[110:111], v12 offset:25600
    v_mfma_f32_32x32x16_bf16 v[112:127], a[212:215], a[52:55], v[112:127]
    ds_read_b64_tr_b16 a[112:113], v11 offset:32768
    ds_read_b64_tr_b16 a[114:115], v11 offset:33792
    ds_read_b64_tr_b16 a[116:117], v12 offset:32768
    s_waitcnt lgkmcnt(15)
    v_mfma_f32_32x32x16_bf16 v[224:239], a[128:131], v[192:195], 0
    ds_read_b64_tr_b16 a[118:119], v12 offset:33792
    ds_read_b64_tr_b16 a[120:121], v11 offset:40960
    ds_read_b64_tr_b16 a[122:123], v11 offset:41984
    v_mfma_f32_32x32x16_bf16 v[240:255], a[128:131], v[208:211], 0
    ds_read_b64_tr_b16 a[124:125], v12 offset:40960
    ds_read_b64_tr_b16 a[126:127], v12 offset:41984
    v_mfma_f32_32x32x16_bf16 v[224:239], a[132:135], v[196:199], v[224:239]
    buffer_load_dwordx4 a[200:203], v19, s[16:19], s89 offen sc1
    v_mfma_f32_32x32x16_bf16 v[240:255], a[132:135], v[212:215], v[240:255]
    buffer_load_dwordx4 a[204:207], v20, s[16:19], s89 offen sc1
    v_mfma_f32_32x32x16_bf16 v[224:239], a[136:139], v[200:203], v[224:239]
    buffer_load_dwordx4 a[208:211], v19, s[16:19], s90 offen sc1
    v_mfma_f32_32x32x16_bf16 v[240:255], a[136:139], v[216:219], v[240:255]
    buffer_load_dwordx4 a[212:215], v20, s[16:19], s90 offen sc1
    v_mfma_f32_32x32x16_bf16 v[224:239], a[140:143], v[204:207], v[224:239]
    v_mfma_f32_32x32x16_bf16 v[240:255], a[140:143], v[220:223], v[240:255]
    v_mfma_f32_32x32x16_bf16 v[64:79], a[216:219], a[56:59], v[64:79]
    v_mfma_f32_32x32x16_bf16 v[80:95], a[216:219], a[60:63], v[80:95]
    buffer_load_dwordx4 a[216:219], v19, s[16:19], s91 offen sc1
    v_mfma_f32_32x32x16_bf16 v[96:111], a[220:223], a[56:59], v[96:111]
    s_nop 7
    v_cvt_pk_bf16_f32 v32, v224, v240
    v_cvt_pk_bf16_f32 v33, v226, v242
    v_cvt_pk_bf16_f32 v34, v228, v244
    v_cvt_pk_bf16_f32 v35, v230, v246
    v_mfma_f32_32x32x16_bf16 v[112:127], a[220:223], a[60:63], v[112:127]
    buffer_load_dwordx4 a[220:223], v20, s[16:19], s91 offen sc1
    v_mfma_f32_32x32x16_bf16 v[64:79], a[224:227], a[64:67], v[64:79]
    v_cvt_pk_bf16_f32 v36, v225, v241
    v_cvt_pk_bf16_f32 v37, v227, v243
    v_cvt_pk_bf16_f32 v38, v229, v245
    v_cvt_pk_bf16_f32 v39, v231, v247
    v_mfma_f32_32x32x16_bf16 v[80:95], a[224:227], a[68:71], v[80:95]
    v_cvt_pk_bf16_f32 v40, v232, v248
    v_cvt_pk_bf16_f32 v41, v234, v250
    v_cvt_pk_bf16_f32 v42, v236, v252
    v_cvt_pk_bf16_f32 v43, v238, v254
    v_mfma_f32_32x32x16_bf16 v[96:111], a[228:231], a[64:67], v[96:111]
    v_cvt_pk_bf16_f32 v44, v233, v249
    v_cvt_pk_bf16_f32 v45, v235, v251
    v_cvt_pk_bf16_f32 v46, v237, v253
    v_cvt_pk_bf16_f32 v47, v239, v255
    v_mfma_f32_32x32x16_bf16 v[112:127], a[228:231], a[68:71], v[112:127]
    buffer_load_dwordx4 v[48:51], v4, s[4:7], s59 offen offset:0
    v_mfma_f32_32x32x16_bf16 v[64:79], v[32:35], v[160:163], v[64:79]
    buffer_load_dwordx4 v[52:55], v4, s[4:7], s59 offen offset:1024
    v_mfma_f32_32x32x16_bf16 v[80:95], v[32:35], v[164:167], v[80:95]
    v_mfma_f32_32x32x16_bf16 v[96:111], v[36:39], v[160:163], v[96:111]
    v_mfma_f32_32x32x16_bf16 v[112:127], v[36:39], v[164:167], v[112:127]
    s_waitcnt vmcnt(10)
    ds_read_b64_tr_b16 a[144:145], v15 offset:12288
    ds_read_b64_tr_b16 a[146:147], v15 offset:12544
    ds_read_b64_tr_b16 a[148:149], v15 offset:13312
    v_mfma_f32_32x32x16_bf16 v[64:79], v[40:43], v[168:171], v[64:79]
    ds_read_b64_tr_b16 a[150:151], v15 offset:13568
    ds_read_b64_tr_b16 a[152:153], v15 offset:14336
    ds_read_b64_tr_b16 a[154:155], v15 offset:14592
    v_mfma_f32_32x32x16_bf16 v[80:95], v[40:43], v[172:175], v[80:95]
    ds_read_b64_tr_b16 a[156:157], v15 offset:15360
    ds_read_b64_tr_b16 a[158:159], v15 offset:15616
    v_mfma_f32_32x32x16_bf16 v[96:111], v[44:47], v[168:171], v[96:111]
    v_mfma_f32_32x32x16_bf16 v[112:127], v[44:47], v[172:175], v[112:127]
    s_waitcnt lgkmcnt(8)
    s_barrier
    v_mfma_f32_32x32x16_bf16 v[64:79], a[232:235], a[72:75], v[64:79]
    v_mfma_f32_32x32x16_bf16 v[80:95], a[232:235], a[76:79], v[80:95]
    v_mfma_f32_32x32x16_bf16 v[96:111], a[236:239], a[72:75], v[96:111]
    v_mfma_f32_32x32x16_bf16 v[112:127], a[236:239], a[76:79], v[112:127]
    s_waitcnt lgkmcnt(6)
    v_mfma_f32_32x32x16_bf16 v[224:239], a[144:147], v[192:195], 0
    v_mfma_f32_32x32x16_bf16 v[240:255], a[144:147], v[208:211], 0
    s_waitcnt lgkmcnt(4)
    v_mfma_f32_32x32x16_bf16 v[224:239], a[148:151], v[196:199], v[224:239]
    v_mfma_f32_32x32x16_bf16 v[240:255], a[148:151], v[212:215], v[240:255]
    s_waitcnt lgkmcnt(2)
    v_mfma_f32_32x32x16_bf16 v[224:239], a[152:155], v[200:203], v[224:239]
    v_mfma_f32_32x32x16_bf16 v[240:255], a[152:155], v[216:219], v[240:255]
    s_waitcnt lgkmcnt(0)
    v_mfma_f32_32x32x16_bf16 v[224:239], a[156:159], v[204:207], v[224:239]
    v_mfma_f32_32x32x16_bf16 v[240:255], a[156:159], v[220:223], v[240:255]
    v_mfma_f32_32x32x16_bf16 v[64:79], a[240:243], a[80:83], v[64:79]
    v_mfma_f32_32x32x16_bf16 v[80:95], a[240:243], a[84:87], v[80:95]
    v_mfma_f32_32x32x16_bf16 v[96:111], a[244:247], a[80:83], v[96:111]
    s_nop 8
    v_cvt_pk_bf16_f32 v32, v224, v240
    v_cvt_pk_bf16_f32 v33, v226, v242
    v_cvt_pk_bf16_f32 v34, v228, v244
    v_cvt_pk_bf16_f32 v35, v230, v246
    v_mfma_f32_32x32x16_bf16 v[112:127], a[244:247], a[84:87], v[112:127]
    v_cvt_pk_bf16_f32 v36, v225, v241
    v_cvt_pk_bf16_f32 v37, v227, v243
    v_cvt_pk_bf16_f32 v38, v229, v245
    v_cvt_pk_bf16_f32 v39, v231, v247
    v_mfma_f32_32x32x16_bf16 v[64:79], a[248:251], a[88:91], v[64:79]
    v_cvt_pk_bf16_f32 v40, v232, v248
    v_cvt_pk_bf16_f32 v41, v234, v250
    v_cvt_pk_bf16_f32 v42, v236, v252
    v_cvt_pk_bf16_f32 v43, v238, v254
    v_mfma_f32_32x32x16_bf16 v[80:95], a[248:251], a[92:95], v[80:95]
    v_cvt_pk_bf16_f32 v44, v233, v249
    v_cvt_pk_bf16_f32 v45, v235, v251
    v_cvt_pk_bf16_f32 v46, v237, v253
    v_cvt_pk_bf16_f32 v47, v239, v255
    v_mfma_f32_32x32x16_bf16 v[96:111], a[252:255], a[88:91], v[96:111]
    v_mfma_f32_32x32x16_bf16 v[112:127], a[252:255], a[92:95], v[112:127]
    v_mfma_f32_32x32x16_bf16 v[64:79], v[32:35], v[176:179], v[64:79]
    v_mfma_f32_32x32x16_bf16 v[80:95], v[32:35], v[180:183], v[80:95]
    v_mfma_f32_32x32x16_bf16 v[96:111], v[36:39], v[176:179], v[96:111]
    v_mfma_f32_32x32x16_bf16 v[112:127], v[36:39], v[180:183], v[112:127]
    v_mfma_f32_32x32x16_bf16 v[64:79], v[40:43], v[184:187], v[64:79]
    v_mfma_f32_32x32x16_bf16 v[80:95], v[40:43], v[188:191], v[80:95]
    v_mfma_f32_32x32x16_bf16 v[96:111], v[44:47], v[184:187], v[96:111]
    v_mfma_f32_32x32x16_bf16 v[112:127], v[44:47], v[188:191], v[112:127]
    s_waitcnt vmcnt(8)
    v_mfma_f32_32x32x16_bf16 v[64:79], a[192:195], a[96:99], v[64:79]
    v_mfma_f32_32x32x16_bf16 v[80:95], a[192:195], a[100:103], v[80:95]
    v_mfma_f32_32x32x16_bf16 v[96:111], a[196:199], a[96:99], v[96:111]
    v_mfma_f32_32x32x16_bf16 v[112:127], a[196:199], a[100:103], v[112:127]
    s_mul_i32 m0, s33, 16448
    s_waitcnt vmcnt(2)
    v_mfma_f32_32x32x16_bf16 v[64:79], a[200:203], a[104:107], v[64:79]
    s_waitcnt vmcnt(0)
    v_lshlrev_b32 v224, 16, v48
    v_and_b32 v225, 0xffff0000, v48
    v_lshlrev_b32 v226, 16, v49
    v_and_b32 v227, 0xffff0000, v49
    v_lshlrev_b32 v228, 16, v50
    v_mfma_f32_32x32x16_bf16 v[64:79], a[208:211], a[112:115], v[64:79]
    v_and_b32 v229, 0xffff0000, v50
    v_lshlrev_b32 v230, 16, v51
    v_and_b32 v231, 0xffff0000, v51
    v_lshlrev_b32 v232, 16, v52
    v_and_b32 v233, 0xffff0000, v52
    v_lshlrev_b32 v234, 16, v53
    v_mfma_f32_32x32x16_bf16 v[64:79], a[216:219], a[120:123], v[64:79]
    v_and_b32 v235, 0xffff0000, v53
    v_lshlrev_b32 v236, 16, v54
    v_and_b32 v237, 0xffff0000, v54
    v_lshlrev_b32 v238, 16, v55
    v_and_b32 v239, 0xffff0000, v55
    v_mfma_f32_32x32x16_bf16 v[80:95], a[200:203], a[108:111], v[80:95]
    v_mfma_f32_32x32x16_bf16 v[80:95], a[208:211], a[116:119], v[80:95]
    v_mfma_f32_32x32x16_bf16 v[80:95], a[216:219], a[124:127], v[80:95]
    v_mfma_f32_32x32x16_bf16 v[96:111], a[204:207], a[104:107], v[96:111]
    s_nop 2
    ds_write_addtid_b32 v64 offset:0
    ds_write_addtid_b32 v65 offset:256
    ds_write_addtid_b32 v66 offset:512
    ds_write_addtid_b32 v67 offset:768
    ds_write_addtid_b32 v68 offset:1024
    v_mfma_f32_32x32x16_bf16 v[96:111], a[212:215], a[112:115], v[96:111]
    ds_write_addtid_b32 v69 offset:1280
    ds_write_addtid_b32 v70 offset:1536
    ds_write_addtid_b32 v71 offset:1792
    ds_write_addtid_b32 v72 offset:2048
    ds_write_addtid_b32 v73 offset:2304
    ds_write_addtid_b32 v74 offset:2560
    v_mfma_f32_32x32x16_bf16 v[96:111], a[220:223], a[120:123], v[96:111]
    ds_write_addtid_b32 v75 offset:2816
    ds_write_addtid_b32 v76 offset:3072
    ds_write_addtid_b32 v77 offset:3328
    ds_write_addtid_b32 v78 offset:3584
    ds_write_addtid_b32 v79 offset:3840
    v_mfma_f32_32x32x16_bf16 v[112:127], a[204:207], a[108:111], v[112:127]
    ds_write_addtid_b32 v80 offset:4112
    ds_write_addtid_b32 v81 offset:4368
    ds_write_addtid_b32 v82 offset:4624
    ds_write_addtid_b32 v83 offset:4880
    ds_write_addtid_b32 v84 offset:5136
    v_mfma_f32_32x32x16_bf16 v[112:127], a[212:215], a[116:119], v[112:127]
    ds_write_addtid_b32 v85 offset:5392
    ds_write_addtid_b32 v86 offset:5648
    ds_write_addtid_b32 v87 offset:5904
    ds_write_addtid_b32 v88 offset:6160
    ds_write_addtid_b32 v89 offset:6416
    ds_write_addtid_b32 v90 offset:6672
    v_mfma_f32_32x32x16_bf16 v[112:127], a[220:223], a[124:127], v[112:127]
    ds_write_addtid_b32 v91 offset:6928
    ds_write_addtid_b32 v92 offset:7184
    ds_write_addtid_b32 v93 offset:7440
    ds_write_addtid_b32 v94 offset:7696
    ds_write_addtid_b32 v95 offset:7952
    ds_write_addtid_b32 v96 offset:8224
    ds_write_addtid_b32 v97 offset:8480
    ds_write_addtid_b32 v98 offset:8736
    ds_write_addtid_b32 v99 offset:8992
    ds_write_addtid_b32 v100 offset:9248
    ds_write_addtid_b32 v101 offset:9504
    ds_write_addtid_b32 v102 offset:9760
    ds_write_addtid_b32 v103 offset:10016
    ds_write_addtid_b32 v104 offset:10272
    ds_write_addtid_b32 v105 offset:10528
    ds_write_addtid_b32 v106 offset:10784
    ds_write_addtid_b32 v107 offset:11040
    ds_write_addtid_b32 v108 offset:11296
    ds_write_addtid_b32 v109 offset:11552
    ds_write_addtid_b32 v110 offset:11808
    ds_write_addtid_b32 v111 offset:12064
    ds_write_addtid_b32 v112 offset:12336
    ds_write_addtid_b32 v113 offset:12592
    ds_write_addtid_b32 v114 offset:12848
    ds_write_addtid_b32 v115 offset:13104
    ds_write_addtid_b32 v116 offset:13360
    ds_write_addtid_b32 v117 offset:13616
    ds_write_addtid_b32 v118 offset:13872
    ds_write_addtid_b32 v119 offset:14128
    ds_write_addtid_b32 v120 offset:14384
    ds_write_addtid_b32 v121 offset:14640
    ds_write_addtid_b32 v122 offset:14896
    ds_write_addtid_b32 v123 offset:15152
    ds_write_addtid_b32 v124 offset:15408
    ds_write_addtid_b32 v125 offset:15664
    ds_write_addtid_b32 v126 offset:15920
    ds_write_addtid_b32 v127 offset:16176
    s_waitcnt lgkmcnt(0)
    s_barrier
    ds_read_b128 v[128:131], v5 offset:0
    ds_read_b128 v[132:135], v5 offset:16
    ds_read_b128 v[136:139], v5 offset:16448
    ds_read_b128 v[140:143], v5 offset:16464
    ds_read_b128 v[144:147], v5 offset:32896
    ds_read_b128 v[148:151], v5 offset:32912
    ds_read_b128 v[152:155], v5 offset:49344
    ds_read_b128 v[156:159], v5 offset:49360
    ds_read_b128 v[160:163], v5 offset:8224
    ds_read_b128 v[164:167], v5 offset:8240
    ds_read_b128 v[168:171], v5 offset:24672
    ds_read_b128 v[172:175], v5 offset:24688
    ds_read_b128 v[176:179], v5 offset:41120
    ds_read_b128 v[180:183], v5 offset:41136
    ds_read_b128 v[184:187], v5 offset:57568
    ds_read_b128 v[188:191], v5 offset:57584
    s_waitcnt lgkmcnt(14)
    v_pk_add_f32 v[224:225], v[224:225], v[128:129]
    v_pk_add_f32 v[226:227], v[226:227], v[130:131]
    v_pk_add_f32 v[228:229], v[228:229], v[132:133]
    v_pk_add_f32 v[230:231], v[230:231], v[134:135]
    s_waitcnt lgkmcnt(12)
    v_pk_add_f32 v[224:225], v[224:225], v[136:137]
    v_pk_add_f32 v[226:227], v[226:227], v[138:139]
    v_pk_add_f32 v[228:229], v[228:229], v[140:141]
    v_pk_add_f32 v[230:231], v[230:231], v[142:143]
    s_waitcnt lgkmcnt(10)
    v_pk_add_f32 v[224:225], v[224:225], v[144:145]
    v_pk_add_f32 v[226:227], v[226:227], v[146:147]
    v_pk_add_f32 v[228:229], v[228:229], v[148:149]
    v_pk_add_f32 v[230:231], v[230:231], v[150:151]
    s_waitcnt lgkmcnt(8)
    v_pk_add_f32 v[224:225], v[224:225], v[152:153]
    v_pk_add_f32 v[226:227], v[226:227], v[154:155]
    v_pk_add_f32 v[228:229], v[228:229], v[156:157]
    v_pk_add_f32 v[230:231], v[230:231], v[158:159]
    v_cvt_pk_bf16_f32 v80, v224, v225
    v_cvt_pk_bf16_f32 v81, v226, v227
    v_cvt_pk_bf16_f32 v82, v228, v229
    v_cvt_pk_bf16_f32 v83, v230, v231
    buffer_store_dwordx4 v[80:83], v4, s[28:31], s59 offen offset:0 sc1
    s_waitcnt lgkmcnt(6)
    v_pk_add_f32 v[232:233], v[232:233], v[160:161]
    v_pk_add_f32 v[234:235], v[234:235], v[162:163]
    v_pk_add_f32 v[236:237], v[236:237], v[164:165]
    v_pk_add_f32 v[238:239], v[238:239], v[166:167]
    s_waitcnt lgkmcnt(4)
    v_pk_add_f32 v[232:233], v[232:233], v[168:169]
    v_pk_add_f32 v[234:235], v[234:235], v[170:171]
    v_pk_add_f32 v[236:237], v[236:237], v[172:173]
    v_pk_add_f32 v[238:239], v[238:239], v[174:175]
    s_waitcnt lgkmcnt(2)
    v_pk_add_f32 v[232:233], v[232:233], v[176:177]
    v_pk_add_f32 v[234:235], v[234:235], v[178:179]
    v_pk_add_f32 v[236:237], v[236:237], v[180:181]
    v_pk_add_f32 v[238:239], v[238:239], v[182:183]
    s_waitcnt lgkmcnt(0)
    v_pk_add_f32 v[232:233], v[232:233], v[184:185]
    v_pk_add_f32 v[234:235], v[234:235], v[186:187]
    v_pk_add_f32 v[236:237], v[236:237], v[188:189]
    v_pk_add_f32 v[238:239], v[238:239], v[190:191]
    v_cvt_pk_bf16_f32 v84, v232, v233
    v_cvt_pk_bf16_f32 v85, v234, v235
    v_cvt_pk_bf16_f32 v86, v236, v237
    v_cvt_pk_bf16_f32 v87, v238, v239
    buffer_store_dwordx4 v[84:87], v4, s[28:31], s59 offen offset:1024 sc1
    s_or_b32 s50, s2, s33
    s_cmp_lg_u32 s50, 0
    s_cbranch_scc1 L_nq_26
    s_mov_b32 s50, 0
    v_mov_b32 v62, 0
    v_mov_b32 v63, s32
    s_mov_b64 exec, 1
    buffer_store_dword v63, v62, s[16:19], s50 offen sc1
    s_mov_b64 exec, -1
L_nq_26:
L_end:
    s_endpgm
L_again_2:
    s_mov_b32 s49, 0
L_loop_4:
    buffer_load_dwordx4 v[192:195], v62, s[16:19], s63 offen sc1
    buffer_load_dwordx4 v[212:215], v62, s[16:19], s99 offen sc1
    s_waitcnt vmcnt(0)
    v_xor_b32 v61, s32, v193
    v_xor_b32 v63, s32, v195
    v_bitop3_b32 v61, v213, s32, v61 bitop3:0xbe
    v_bitop3_b32 v63, v215, s32, v63 bitop3:0xbe
    v_or_b32 v61, v61, v63
    v_cmp_ne_u32 vcc, 0, v61
    s_add_u32 s49, s49, 1
    s_nop 3
    s_cbranch_vccz L_back_3
    s_cmp_gt_u32 s49, 20000
    s_cbranch_scc0 L_loop_4
    s_branch L_back_3
L_again_5:
    s_mov_b32 s49, 0
L_loop_7:
    buffer_load_dwordx4 v[196:199], v26, s[16:19], s57 offen offset:0 sc1
    buffer_load_dwordx4 v[200:203], v26, s[16:19], s57 offen offset:1024 sc1
    buffer_load_dwordx4 v[204:207], v26, s[16:19], s57 offen offset:2048 sc1
    buffer_load_dwordx4 v[208:211], v26, s[16:19], s57 offen offset:3072 sc1
    s_waitcnt vmcnt(0)
    v_xor_b32 v61, s32, v197
    v_xor_b32 v63, s32, v199
    v_bitop3_b32 v61, v201, s32, v61 bitop3:0xbe
    v_bitop3_b32 v63, v203, s32, v63 bitop3:0xbe
    v_bitop3_b32 v61, v205, s32, v61 bitop3:0xbe
    v_bitop3_b32 v63, v207, s32, v63 bitop3:0xbe
    v_bitop3_b32 v61, v209, s32, v61 bitop3:0xbe
    v_bitop3_b32 v63, v211, s32, v63 bitop3:0xbe
    v_or_b32 v61, v61, v63
    v_cmp_ne_u32 vcc, 0, v61
    s_add_u32 s49, s49, 1
    s_nop 3
    s_cbranch_vccz L_back_6
    s_cmp_gt_u32 s49, 20000
    s_cbranch_scc0 L_loop_7
    s_branch L_back_6
L_again_8:
    s_mov_b32 s49, 0
L_loop_10:
    buffer_load_dword v229, v228, s[16:19], s63 offen sc1
    s_waitcnt vmcnt(0)
    v_cmp_ne_u32 vcc, s32, v229
    s_add_u32 s49, s49, 1
    s_nop 3
    s_cbranch_vccz L_back_9
    s_cmp_gt_u32 s49, 20000
    s_cbranch_scc0 L_loop_10
    s_branch L_back_9
L_again_11:
    s_mov_b32 s49, 0
L_loop_13:
    buffer_load_dword v7, v6, s[16:19], s58 offen sc1
    s_waitcnt vmcnt(0)
    v_cmp_ne_u32 vcc, s32, v7
    s_add_u32 s49, s49, 1
    s_nop 3
    s_cbranch_vccz L_back_12
    s_cmp_gt_u32 s49, 20000
    s_cbranch_scc0 L_loop_13
    s_branch L_back_12
L_again_14:
    s_mov_b32 s49, 0
L_loop_16:
    buffer_load_dwordx4 v[192:195], v62, s[16:19], s63 offen sc1
    s_waitcnt vmcnt(0)
    v_cmp_ne_u32 vcc, s32, v193
    v_cmp_ne_u32 s[54:55], s32, v195
    s_nop 1
    s_or_b64 vcc, vcc, s[54:55]
    s_add_u32 s49, s49, 1
    s_nop 0
    s_cbranch_vccz L_back_15
    s_cmp_gt_u32 s49, 20000
    s_cbranch_scc0 L_loop_16
    s_branch L_back_15
L_again_17:
    s_mov_b32 s49, 0
L_loop_19:
    buffer_load_dword v229, v228, s[16:19], s63 offen sc1
    s_waitcnt vmcnt(0)
    v_cmp_ne_u32 vcc, s32, v229
    s_add_u32 s49, s49, 1
    s_nop 3
    s_cbranch_vccz L_back_18
    s_cmp_gt_u32 s49, 20000
    s_cbranch_scc0 L_loop_19
    s_branch L_back_18
L_again_20:
    s_mov_b32 s49, 0
L_loop_22:
    buffer_load_dword v7, v6, s[16:19], s58 offen sc1
    s_waitcnt vmcnt(0)
    v_cmp_ne_u32 vcc, s32, v7
    s_add_u32 s49, s49, 1
    s_nop 3
    s_cbranch_vccz L_back_21
    s_cmp_gt_u32 s49, 20000
    s_cbranch_scc0 L_loop_22
    s_branch L_back_21
L_again_23:
    s_mov_b32 s49, 0
L_loop_25:
    buffer_load_dword v7, v26, s[16:19], s58 offen sc1
    s_waitcnt vmcnt(0)
    v_cmp_ne_u32 vcc, s32, v7
    s_add_u32 s49, s49, 1
    s_nop 3
    s_cbranch_vccz L_back_24
    s_cmp_gt_u32 s49, 20000
    s_cbranch_scc0 L_loop_25
    s_branch L_back_24
.section .rodata,"a"
.p2align 6
.amdhsa_kernel parallel_sum__spectral_gfnet__dense_activation_silu__prompt_kernel
  .amdhsa_next_free_vgpr 512
  .amdhsa_next_free_sgpr 102
  .amdhsa_accum_offset 256
  .amdhsa_group_segment_fixed_size 0
  .amdhsa_kernarg_size 72
  .amdhsa_user_sgpr_count 2
  .amdhsa_user_sgpr_kernarg_segment_ptr 1
  .amdhsa_system_sgpr_workgroup_id_x 1
.end_amdhsa_kernel
```
